```python
import torch

def _softmax(x, axis=-1):
    return torch.softmax(x, dim=axis)
def _gelu(x):
    return torch.nn.functional.gelu(x, approximate="tanh")
def _silu(x):
    return torch.nn.functional.silu(x)
def _sigmoid(x):
    return torch.sigmoid(x)
def _layernorm(x, axis=-1, eps=1e-5):
    m = x.mean(dim=axis, keepdim=True)
    v = x.var(dim=axis, keepdim=True, unbiased=False)
    return (x - m) / torch.sqrt(v + eps)
def _scatter_add(tgt, idx, src, axis=0):
    return tgt.clone().index_add_(axis, idx, src)
def _segment_sum(src, seg, n):
    out = torch.zeros((n,) + src.shape[1:], dtype=src.dtype)
    return out.index_add_(0, seg, src)
def _pad(x, pw):
    flat = tuple(v for pair in reversed(pw) for v in pair)
    return torch.nn.functional.pad(x, flat)

kernel_name = 'recurrent_scan__ssm_conv_s4__mixer_s_mlp__prompt'

def setup_inputs():

    _w = (lambda a: (lambda t: t.to(torch.bfloat16) if t.is_floating_point() else t)(torch.as_tensor(a)))
    def _A_setup():
        B, L, D, N = 1, 2048, 512, 128
        A_re = -(lambda _x: torch.exp(torch.as_tensor(_x)))((lambda *s: torch.randn(*s, dtype=torch.bfloat16) * 3.2)(D, N))
        A_im = torch.pi * (lambda *s: torch.randn(*s, dtype=torch.bfloat16) * 0.05)(D, N)
        B_re = (lambda *s: torch.randn(*s, dtype=torch.bfloat16) * 0.1)(D, N)
        B_im = (lambda *s: torch.randn(*s, dtype=torch.bfloat16) * 0.1)(D, N)
        C_re = (lambda *s: torch.randn(*s, dtype=torch.bfloat16) * 0.1)(D, N)
        C_im = (lambda *s: torch.randn(*s, dtype=torch.bfloat16) * 0.1)(D, N)
        log_dt = (lambda *s: torch.randn(*s, dtype=torch.bfloat16) * 0.05)(D) * 0.5 - 4.0
        Dskip = (lambda *s: torch.randn(*s, dtype=torch.bfloat16) * 0.05)(D)
        return {
            "u": _w((lambda *s: torch.randn(*s, dtype=torch.bfloat16) * 0.05)(B, L, D)),
            "A_re": _w(A_re),
            "A_im": _w(A_im),
            "B_re": _w(B_re),
            "B_im": _w(B_im),
            "C_re": _w(C_re),
            "C_im": _w(C_im),
            "log_dt": _w(log_dt),
            "Dskip": _w(Dskip),
        }
    _A_in = _A_setup()

    def _B_setup():
        B, S, D, F = 1, 2048, 512, 1376
        return {
            "x":  _w((lambda *s: torch.randn(*s, dtype=torch.bfloat16) * 0.05)(B, S, D)),
            "w1": _w((lambda *s: torch.randn(*s, dtype=torch.bfloat16) * 3.2)(D, D) * (D ** -0.5)),
            "w2": _w((lambda *s: torch.randn(*s, dtype=torch.bfloat16) * 3.2)(D, D) * (D ** -0.5)),
            "w3": _w((lambda *s: torch.randn(*s, dtype=torch.bfloat16) * 3.2)(D, F) * (D ** -0.5)),
            "w4": _w((lambda *s: torch.randn(*s, dtype=torch.bfloat16) * 1.6)(F, D) * (F ** -0.5)),
        }
    _B_in = _B_setup()

    return {
        "A_u": _A_in["u"],
        "A_A_re": _A_in["A_re"],
        "A_A_im": _A_in["A_im"],
        "A_B_re": _A_in["B_re"],
        "A_B_im": _A_in["B_im"],
        "A_C_re": _A_in["C_re"],
        "A_C_im": _A_in["C_im"],
        "A_log_dt": _A_in["log_dt"],
        "A_Dskip": _A_in["Dskip"],
        "B_x": _B_in["x"],
        "B_w1": _B_in["w1"],
        "B_w2": _B_in["w2"],
        "B_w3": _B_in["w3"],
        "B_w4": _B_in["w4"],
    }

def reference(A_u, A_A_re, A_A_im, A_B_re, A_B_im, A_C_re, A_C_im, A_log_dt, A_Dskip, B_x, B_w1, B_w2, B_w3, B_w4):
    def _A_ref(u, A_re, A_im, B_re, B_im, C_re, C_im, log_dt, Dskip):
        Bsz, L, D = u.shape
        dt = torch.exp(log_dt)[:, None]
        A = A_re + 1j * A_im
        Bc = B_re + 1j * B_im
        Cc = C_re + 1j * C_im
        logdA = dt * A
        dB = dt * Bc
        l = (lambda x, dt: x.to(dt))(torch.arange(L), A_re.dtype)
        P = torch.exp(logdA[:, :, None] * l[None, None, :])
        K = torch.einsum("dn,dnl,dn->dl", Cc, P, dB).real
        L2 = 2 * L
        Kp = _pad(K, ((0, 0), (0, L)))
        up = (lambda x, *d: x.permute(*d))(u, 0, 2, 1)
        up = _pad(up, ((0, 0), (0, 0), (0, L)))
        Kf = (lambda x, axes=(-2,-1): torch.fft.rfft2(x.float(), dim=axes))(Kp[:, None, :], axes=(-2, -1))
        Uf = (lambda x, axes=(-2,-1): torch.fft.rfft2(x.float(), dim=axes))(up[:, :, None, :], axes=(-2, -1))
        Yf = Uf * Kf[None, :, :, :]
        y = (lambda x, s, axes=(-2,-1): torch.fft.irfft2(x, s=s, dim=axes).to(torch.bfloat16))(Yf, (1, L2), axes=(-2, -1))[:, :, 0, :L]
        y = (lambda x, *d: x.permute(*d))(y, 0, 2, 1) + u * Dskip[None, None, :]
        return y

    def _B_ref(x, w1, w2, w3, w4):
        B, S, D = x.shape
        h = _gelu(_layernorm(x, axis=-1) @ w1)
        c = D // 4
        g0 = _pad(h[:, :, 0*c:1*c], ((0, 0), (1, 0), (0, 0)))[:, :S, :]
        g1 = _pad(h[:, :, 1*c:2*c], ((0, 0), (0, 1), (0, 0)))[:, 1:, :]
        g2 = _pad(h[:, :, 2*c:3*c], ((0, 0), (2, 0), (0, 0)))[:, :S, :]
        g3 = _pad(h[:, :, 3*c:   ], ((0, 0), (0, 2), (0, 0)))[:, 2:, :]
        hs = torch.concatenate([g0, g1, g2, g3], axis=-1) @ w2
        x1 = x + hs
        h2 = _gelu(_layernorm(x1, axis=-1) @ w3) @ w4
        return x1 + h2

    x = A_u
    xn = _layernorm(x, axis=-1)
    s = _A_ref(xn, A_A_re, A_A_im, A_B_re, A_B_im, A_C_re, A_C_im, A_log_dt, A_Dskip)
    g = _silu(_B_ref(xn, B_w1, B_w2, B_w3, B_w4))
    return x + s * g
```

```asm
; @launch grid=(256,1,1) block=(512,1,1) lds=163840
.amdgcn_target "amdgcn-amd-amdhsa--gfx950"
.text
.globl recurrent_scan__ssm_conv_s4__mixer_s_mlp__prompt_kernel
.p2align 8
.type recurrent_scan__ssm_conv_s4__mixer_s_mlp__prompt_kernel,@function
recurrent_scan__ssm_conv_s4__mixer_s_mlp__prompt_kernel:
  s_load_dwordx16 s[36:51], s[0:1], 0
  s_load_dwordx8 s[56:63], s[0:1], 80
  s_load_dwordx2 s[90:91], s[0:1], 128
  s_load_dwordx2 s[52:53], s[0:1], 64
  s_load_dwordx2 s[64:65], s[0:1], 112
  s_cmp_ge_u32 s2, 256
  s_cbranch_scc1 L_exit
  v_lshrrev_b32 v3, 6, v0
  v_and_b32 v0, 63, v0
  v_readfirstlane_b32 s3, v3
  s_getpc_b64 s[72:73]
L_pc:
  s_lshr_b32 s4, s2, 3
  s_and_b32 s4, s4, 7
  v_lshlrev_b32 v5, 7, v0
  v_lshlrev_b32 v4, 4, v0
  s_cmp_lg_u32 s3, 7
  s_cbranch_scc1 L_nocode
  s_and_b32 s70, s4, 3
  s_lshl_b32 s70, s70, 13
  v_add_u32 v6, s70, v5
  v_min_u32 v6, L_codeend-L_pc-4, v6
  global_load_dword v127, v6, s[72:73]
L_nocode:
  s_and_b32 s5, s2, 7
  s_lshl_b32 s5, s5, 2
  s_lshr_b32 s70, s2, 6
  s_add_u32 s5, s5, s70
  s_lshl_b32 s6, s5, 3
  s_lshr_b32 s70, s4, 2
  s_add_u32 s7, s70, 1
  s_sub_u32 s70, 0, s7
  s_bitcmp1_b32 s4, 1
  s_cselect_b32 s7, s7, s70
  v_mov_b32 v1, 0
  v_mov_b32 v2, 1
  s_cmp_lt_u32 s3, 4
  s_cbranch_scc1 L_A
  s_setprio 3
  s_sub_u32 s3, s3, 4
  s_bfe_u32 s70, s3, 0x10001
  s_lshl_b32 s74, s4, 6
  s_lshl_b32 s79, s5, 1
  s_add_u32 s74, s74, s79
  s_add_u32 s74, s74, s70
  s_and_b32 s71, s3, 1
  s_lshl_b32 s70, s74, 8
  s_lshl_b32 s79, s71, 7
  s_add_u32 s70, s70, s79
  v_lshl_add_u32 v8, v0, 1, s70
  s_lshl_b32 s76, s74, 1
  s_andn2_b32 s76, s76, 3
  s_add_u32 s70, s6, s4
  s_lshl_b32 s71, s70, 13
  v_add_u32 v6, s71, v5
  s_lshl_b32 s71, s70, 11
  v_add_u32 v7, s71, v5
  v_lshlrev_b32 v10, 2, v0
  v_mov_b32 v11, 0
  ds_write_b32 v10, v11 offset:30016
  s_lshl_b32 s70, s5, 10
  s_add_u32 s70, s70, 65536
  v_add_u32 v10, s70, v5
  v_lshrrev_b32 v12, 2, v0
  v_mul_u32_u24 v12, 2688, v12
  v_add_u32 v12, v12, v4
  s_mul_i32 s73, s5, 44032
  s_mul_i32 s79, s4, 352
  s_add_u32 s73, s73, s79
  s_mul_i32 s79, s3, 192
  s_add_u32 s73, s73, s79
  s_cmp_ge_u32 s4, 6
  s_cselect_b32 s70, 32, 0
  s_sub_u32 s73, s73, s70
  v_lshrrev_b32 v60, 3, v0
  v_mul_u32_u24 v60, 896, v60
  v_add_u32 v60, v60, v4
  s_cmp_lt_i32 s7, 0
  s_cselect_b32 s75, 64, -2
  s_add_u32 s75, s75, s7
  s_lshl_b32 s70, s5, 16
  s_lshl_b32 s79, s75, 10
  s_add_u32 s70, s70, s79
  v_lshl_add_u32 v61, v0, 5, s70
  s_lshl_b32 s77, s5, 16
  s_lshl_b32 s79, s4, 7
  s_add_u32 s77, s77, s79
  s_lshl_b32 s79, s3, 14
  s_add_u32 s77, s77, s79
  s_lshl_b32 s71, s3, 11
  s_add_u32 m0, s71, 16640
  s_waitcnt lgkmcnt(0)
  global_load_ushort v48, v8, s[38:39] nt
  global_load_ushort v49, v8, s[40:41] nt
  global_load_ushort v50, v8, s[42:43] nt
  global_load_ushort v51, v8, s[44:45] nt
  global_load_ushort v52, v8, s[46:47] nt
  global_load_ushort v53, v8, s[48:49] nt
  s_load_dword s66, s[50:51], s76
  s_load_dword s67, s[52:53], s76
  s_load_dword s68, s[90:91], 0
  s_mov_b32 s8, s36
  s_mov_b32 s9, s37
  s_mov_b32 s10, 2097152
  s_mov_b32 s11, 0x20000
  s_cmp_eq_u32 s3, 2
  s_cbranch_scc1 L_f2b
  s_cmp_eq_u32 s3, 3
  s_cbranch_scc1 L_f2c
  s_mov_b32 s20, s60
  s_mov_b32 s21, s61
  s_mov_b32 s22, 1409024
  s_mov_b32 s23, 0x20000
  buffer_load_dwordx4 v[240:243], v12, s[20:23], s73 offen offset:0 nt
  buffer_load_dwordx4 v[244:247], v12, s[20:23], s73 offen offset:64 nt
  buffer_load_dwordx4 v[248:251], v12, s[20:23], s73 offen offset:128 nt
  s_branch L_f2d
L_f2b:
  global_load_dword v56, v6, s[36:37] nt
  s_mov_b64 exec, 0xffff
  global_load_dword v57, v7, s[56:57]
  global_load_dword v58, v7, s[58:59]
  s_branch L_f2d
L_f2c:
  buffer_load_dwordx4 v[232:235], v61, s[8:11], 0 offen offset:0
  buffer_load_dwordx4 v[236:239], v61, s[8:11], 0 offen offset:16
  s_mov_b64 exec, 0x1f
  global_load_dword v56, v10, s[90:91] sc1
L_f2d:
  s_mov_b64 exec, -1
  buffer_load_dwordx4 v60, s[8:11], s77 offen lds
  s_addk_i32 m0, 1024
  s_addk_i32 s77, 8192
  buffer_load_dwordx4 v60, s[8:11], s77 offen lds
  s_barrier
  s_setprio 1
  s_branch L_B
L_exit:
  s_endpgm
L_A:
  v_lshrrev_b32 v10, 4, v0
  v_and_b32 v11, 15, v0
  v_xor_b32 v11, v11, v10
  v_lshlrev_b32 v11, 4, v11
  s_lshl_b32 s70, s5, 16
  s_lshl_b32 s79, s7, 10
  s_add_u32 s70, s70, s79
  s_lshl_b32 s79, s3, 8
  s_add_u32 s70, s70, s79
  v_lshl_add_u32 v12, v10, 10, s70
  v_add_u32 v56, v12, v11
  v_xor_b32 v13, 64, v11
  v_add_u32 v13, 4096, v13
  v_add_u32 v57, v12, v13
  v_xor_b32 v13, 128, v11
  v_add_u32 v13, 8192, v13
  v_add_u32 v58, v12, v13
  v_xor_b32 v13, 192, v11
  v_add_u32 v13, 12288, v13
  v_add_u32 v59, v12, v13
  v_add_u32 v60, 0x4000, v56
  s_mov_b32 s72, 0x4000
  s_mov_b32 s73, 0x8000
  s_mov_b32 s74, 0xc000
  s_lshl_b32 s75, s3, 14
  s_setprio 2
  s_mov_b32 s84, 0x3f803f80
  s_lshl_b32 s76, s3, 17
  s_lshl_b32 s79, s4, 7
  s_add_u32 s76, s76, s79
  s_lshr_b32 s66, s3, 1
  s_and_b32 s67, s3, 1
  v_lshrrev_b32 v100, 5, v0
  v_and_b32 v101, 15, v0
  v_xor_b32 v8, v101, v100
  s_lshl_b32 s70, s66, 13
  s_lshl_b32 s79, s3, 14
  s_add_u32 s70, s70, s79
  v_and_b32 v102, 31, v0
  v_lshl_add_u32 v9, v102, 8, s70
  v_lshl_add_u32 v8, v8, 4, v9
  s_mov_b32 s70, 98304
  v_xor_b32 v9, 0, v8
  v_add_u32 v128, s70, v9
  v_xor_b32 v132, 32, v128
  v_xor_b32 v136, 64, v128
  v_xor_b32 v140, 96, v128
  v_xor_b32 v144, 128, v128
  v_xor_b32 v148, 160, v128
  v_xor_b32 v152, 192, v128
  v_xor_b32 v156, 224, v128
  v_xor_b32 v9, 16384, v8
  v_add_u32 v160, s70, v9
  v_xor_b32 v164, 32, v160
  v_xor_b32 v168, 64, v160
  v_xor_b32 v172, 96, v160
  v_xor_b32 v176, 128, v160
  v_xor_b32 v180, 160, v160
  v_xor_b32 v184, 192, v160
  v_xor_b32 v188, 224, v160
  v_xor_b32 v9, 32768, v8
  v_add_u32 v192, s70, v9
  v_xor_b32 v196, 32, v192
  v_xor_b32 v200, 64, v192
  v_xor_b32 v204, 96, v192
  v_xor_b32 v208, 128, v192
  v_xor_b32 v212, 160, v192
  v_xor_b32 v216, 192, v192
  v_xor_b32 v220, 224, v192
  v_xor_b32 v9, 49152, v8
  v_add_u32 v224, s70, v9
  v_xor_b32 v228, 32, v224
  v_xor_b32 v232, 64, v224
  v_xor_b32 v236, 96, v224
  v_xor_b32 v240, 128, v224
  v_xor_b32 v244, 160, v224
  v_xor_b32 v248, 192, v224
  v_xor_b32 v252, 224, v224
  v_xor_b32 v64, 0x2000, v128
  v_xor_b32 v68, 0x2000, v132
  v_xor_b32 v72, 0x2000, v136
  v_xor_b32 v76, 0x2000, v140
  v_xor_b32 v80, 0x2000, v144
  v_xor_b32 v84, 0x2000, v148
  v_xor_b32 v88, 0x2000, v152
  v_xor_b32 v92, 0x2000, v156
  v_bfe_u32 v103, v0, 2, 2
  v_lshlrev_b32 v9, 7, v103
  v_bfe_u32 v104, v0, 4, 1
  v_lshl_add_u32 v9, v104, 5, v9
  v_and_b32 v105, 3, v0
  v_lshl_add_u32 v9, v105, 3, v9
  v_bfe_u32 v106, v0, 3, 1
  v_lshl_add_u32 v9, v106, 6, v9
  s_lshl_b32 s70, s67, 6
  v_xor_b32 v9, s70, v9
  v_lshl_add_u32 v8, v100, 10, v9
  v_add_u32 v8, s75, v8
  v_xor_b32 v24, 0, v8
  v_xor_b32 v25, 16384, v8
  v_xor_b32 v26, 32768, v8
  v_xor_b32 v27, 49152, v8
  v_lshrrev_b32 v107, 3, v0
  v_lshlrev_b32 v28, 10, v107
  v_and_b32 v108, 7, v0
  v_lshl_add_u32 v28, v108, 4, v28
  v_lshlrev_b32 v8, 6, v104
  v_xor_b32 v28, v28, v8
  v_lshlrev_b32 v29, 2, v0
  s_lshl_b32 s70, s3, 8
  v_add_u32 v31, s70, v29
  s_lshl_b32 s79, s66, 10
  s_add_u32 s70, s70, s79
  v_add_u32 v30, s70, v29
  v_xor_b32 v16, 0x400, v30
  v_mov_b32 v17, v9
  s_waitcnt lgkmcnt(0)
  s_mov_b32 s8, s36
  s_mov_b32 s9, s37
  s_mov_b32 s10, 2097152
  s_mov_b32 s11, 0x20000
  s_barrier
  s_load_dword s68, s[90:91], 0
  s_mov_b32 s12, s56
  s_mov_b32 s13, s57
  s_mov_b32 s14, 524288
  s_mov_b32 s15, 0x20000
  s_mov_b32 s28, s90
  s_mov_b32 s29, s91
  s_mov_b32 s30, 268435456
  s_mov_b32 s31, 0x20000
  s_mov_b32 s16, s58
  s_mov_b32 s17, s59
  s_mov_b32 s18, 524288
  s_mov_b32 s19, 0x20000
  s_mov_b32 s20, s62
  s_mov_b32 s21, s63
  s_mov_b32 s22, 1409024
  s_mov_b32 s23, 0x20000
  s_mul_i32 s36, s5, 49152
  s_lshl_b32 s79, s4, 7
  s_add_u32 s36, s36, s79
  v_lshrrev_b32 v47, 2, v0
  v_mul_u32_u24 v47, 960, v47
  v_add_u32 v47, v47, v4
  s_lshr_b32 s46, s2, 3
  s_lshl_b32 s46, s46, 14
  s_lshl_b32 s79, s3, 12
  s_add_u32 s46, s46, s79
  s_mov_b32 s80, 0x409d30fc
  s_mov_b32 s81, 0x409d30fc
  s_mov_b32 s82, 0x3eeff558
  s_mov_b32 s83, 0x3eeff558
  s_mov_b32 s84, 0x3f803f80
  s_lshl_b32 s25, s5, 10
  s_add_u32 s25, s25, 65536
  s_lshl_b32 s27, s4, 11
  s_add_u32 s27, s27, 32768
  s_and_b32 s42, s4, 1
  s_lshl_b32 s40, s6, 13
  s_lshl_b32 s79, s4, 13
  s_add_u32 s40, s40, s79
  s_lshl_b32 s41, s3, 14
  s_lshl_b32 s79, s6, 13
  s_add_u32 s41, s41, s79
  s_lshl_b32 s79, s42, 13
  s_add_u32 s41, s41, s79
  s_lshl_b32 s43, s4, 4
  s_lshl_b32 s79, s3, 2
  s_add_u32 s43, s43, s79
  s_add_u32 s43, s43, s25
  s_lshl_b32 s44, s3, 5
  s_add_u32 s44, s44, s25
  s_lshl_b32 s47, s3, 11
  s_add_u32 s47, s47, s40
  s_add_u32 s47, s47, 1048576
  s_add_u32 s48, s47, 2097152
  s_lshr_b32 s49, s40, 3
  s_add_u32 s49, s49, 262144
  s_lshl_b32 s79, s3, 8
  s_add_u32 s49, s49, s79
  s_lshl_b32 s50, s6, 10
  s_add_u32 s50, s50, 262144
  s_mul_i32 s51, s3, 45056
  s_mul_i32 s79, s4, 196608
  s_add_u32 s51, s51, s79
  s_add_u32 s51, s51, 17301504
  s_cmp_eq_u32 s3, 3
  s_cselect_b32 s70, 2048, 0
  s_sub_u32 s51, s51, s70
  s_add_u32 s52, s41, 1048576
  s_add_u32 s53, s41, 3145728
  s_mul_i32 s55, s5, 180224
  s_mul_i32 s79, s3, 22528
  s_add_u32 s55, s55, s79
  s_add_u32 s55, s55, 5242880
  s_mul_i32 s39, s4, 270336
  s_mul_i32 s79, s5, 8448
  s_add_u32 s39, s39, s79
  s_mul_i32 s79, s66, 4224
  s_add_u32 s39, s39, s79
  s_lshl_b32 s79, s67, 11
  s_add_u32 s39, s39, s79
  s_add_u32 s39, s39, 13369344
  s_mul_i32 s58, s5, 180224
  s_mul_i32 s79, s4, 11264
  s_add_u32 s58, s58, s79
  s_lshl_b32 s79, s66, 11
  s_add_u32 s58, s58, s79
  s_mul_i32 s79, s67, 90112
  s_add_u32 s58, s58, s79
  s_add_u32 s58, s58, 5251072
  s_cmp_ge_u32 s3, 2
  s_cselect_b32 s59, 0x80000000, s58
  s_cselect_b32 s61, 0xff, -1
  s_and_b32 s61, s61, 0xffff
  s_or_b32 s70, s4, 2
  s_lshl_b32 s70, s70, 1
  s_add_u32 s70, s70, s66
  s_cmp_eq_u32 s70, 15
  s_cselect_b32 s60, 0, -1
  s_lshr_b32 s70, s5, 3
  s_and_b32 s71, s5, 7
  s_lshl_b32 s26, s70, 7
  s_lshl_b32 s79, s71, 2
  s_add_u32 s26, s26, s79
  s_add_u32 s26, s26, s27
  s_lshl_b32 s70, s42, 13
  s_add_u32 s70, s70, 98304
  v_lshl_add_u32 v34, v100, 9, v17
  v_add_u32 v34, s70, v34
  v_xor_b32 v35, 0x2000, v34
  s_lshl_b32 s70, s66, 10
  s_add_u32 s70, s70, 24832
  v_lshl_add_u32 v32, v102, 2, s70
  s_lshl_b32 s70, s67, 8
  v_lshl_add_u32 v33, v100, 4, s70
  s_lshl_b32 s70, s66, 12
  s_lshl_b32 s79, s67, 6
  s_add_u32 s70, s70, s79
  v_lshl_add_u32 v36, v102, 7, s70
  v_lshl_add_u32 v36, v100, 3, v36
  s_lshl_b32 s70, s66, 8
  v_lshl_add_u32 v37, v102, 3, s70
  s_lshl_b32 s70, s66, 12
  s_add_u32 s70, s70, 32768
  v_add_u32 v38, s70, v4
  s_lshl_b32 s70, s66, 9
  s_lshl_b32 s79, s67, 6
  s_add_u32 s70, s70, s79
  v_lshl_add_u32 v39, v104, 8, s70
  v_lshl_add_u32 v39, v100, 7, v39
  v_lshl_add_u32 v39, v101, 2, v39
  s_lshl_b32 s70, s3, 7
  v_lshl_add_u32 v40, v101, 3, s70
  s_lshl_b32 s70, s3, 13
  s_lshl_b32 s79, s67, 12
  s_add_u32 s70, s70, s79
  s_add_u32 s70, s70, 98304
  v_bfe_u32 v109, v0, 1, 4
  v_lshl_add_u32 v43, v109, 4, s70
  v_and_b32 v110, 1, v0
  v_lshl_add_u32 v43, v110, 9, v43
  v_lshl_add_u32 v43, v100, 10, v43
  s_lshl_b32 s70, s66, 9
  s_add_u32 s70, s70, 28992
  v_lshl_add_u32 v44, v100, 4, s70
  s_lshl_b32 s70, s67, 8
  v_lshl_add_u32 v45, v102, 3, s70
  v_lshlrev_b32 v41, 7, v107
  v_lshl_add_u32 v41, v108, 2, v41
  s_add_u32 m0, s75, 98304
  s_nop 0
  buffer_load_dwordx4 v56, s[8:11], 0 offen lds
  s_addk_i32 m0, 1024
  s_nop 0
  buffer_load_dwordx4 v57, s[8:11], 0 offen lds
  s_addk_i32 m0, 1024
  s_nop 0
  buffer_load_dwordx4 v58, s[8:11], 0 offen lds
  s_addk_i32 m0, 1024
  s_nop 0
  buffer_load_dwordx4 v59, s[8:11], 0 offen lds
  s_addk_i32 m0, 1024
  s_nop 0
  buffer_load_dwordx4 v60, s[8:11], 0 offen lds
  s_addk_i32 m0, 1024
  s_nop 0
  buffer_load_dwordx4 v57, s[8:11], s72 offen lds
  s_addk_i32 m0, 1024
  s_nop 0
  buffer_load_dwordx4 v58, s[8:11], s72 offen lds
  s_addk_i32 m0, 1024
  s_nop 0
  buffer_load_dwordx4 v59, s[8:11], s72 offen lds
  s_addk_i32 m0, 1024
  s_nop 0
  buffer_load_dwordx4 v60, s[8:11], s72 offen lds
  s_addk_i32 m0, 1024
  s_nop 0
  buffer_load_dwordx4 v57, s[8:11], s73 offen lds
  s_addk_i32 m0, 1024
  s_nop 0
  buffer_load_dwordx4 v58, s[8:11], s73 offen lds
  s_addk_i32 m0, 1024
  s_nop 0
  buffer_load_dwordx4 v59, s[8:11], s73 offen lds
  s_addk_i32 m0, 1024
  s_nop 0
  buffer_load_dwordx4 v60, s[8:11], s73 offen lds
  s_addk_i32 m0, 1024
  s_nop 0
  buffer_load_dwordx4 v57, s[8:11], s74 offen lds
  s_addk_i32 m0, 1024
  s_nop 0
  buffer_load_dwordx4 v58, s[8:11], s74 offen lds
  s_addk_i32 m0, 1024
  s_nop 0
  buffer_load_dwordx4 v59, s[8:11], s74 offen lds
  s_add_u32 s70, s3, 0
  s_cmp_ge_u32 s70, 3
  s_cselect_b32 s71, 1, 0
  s_lshl_b32 s78, s71, 10
  s_lshl_b32 s79, s70, 10
  s_add_u32 s78, s78, s79
  s_min_u32 s78, s78, 7168
  s_add_u32 m0, s78, 8192
  s_mul_i32 s71, s71, 4294918208
  s_lshl_b32 s79, s70, 14
  s_add_u32 s71, s71, s79
  s_add_u32 s71, s71, s36
  s_cmp_ge_u32 s70, 6
  s_cselect_b32 s71, 0x80000000, s71
  buffer_load_dwordx4 v47, s[20:23], s71 offen nt lds
  s_add_u32 s70, s3, 4
  s_cmp_ge_u32 s70, 3
  s_cselect_b32 s71, 1, 0
  s_lshl_b32 s78, s71, 10
  s_lshl_b32 s79, s70, 10
  s_add_u32 s78, s78, s79
  s_min_u32 s78, s78, 7168
  s_add_u32 m0, s78, 8192
  s_mul_i32 s71, s71, 4294918208
  s_lshl_b32 s79, s70, 14
  s_add_u32 s71, s71, s79
  s_add_u32 s71, s71, s36
  s_cmp_ge_u32 s70, 6
  s_cselect_b32 s71, 0x80000000, s71
  buffer_load_dwordx4 v47, s[20:23], s71 offen nt lds
  v_mov_b32 v48, 0
  v_mov_b32 v49, 0
  v_mov_b32 v50, 0
  v_mov_b32 v51, 0
  v_mov_b32 v60, s84
  v_mov_b32 v61, s84
  v_mov_b32 v62, s84
  v_mov_b32 v63, s84
  s_setprio 2
  s_cmp_eq_u32 s66, 1
  s_cbranch_scc1 TH_1
  s_waitcnt vmcnt(10)
  ds_read_b128 v[128:131], v128
  ds_read_b128 v[132:135], v132
  ds_read_b128 v[136:139], v136
  ds_read_b128 v[140:143], v140
  ds_read_b128 v[144:147], v144
  ds_read_b128 v[148:151], v148
  ds_read_b128 v[152:155], v152
  ds_read_b128 v[156:159], v156
  s_add_u32 m0, s75, 32768
  s_nop 0
  buffer_load_dwordx4 v28, s[12:15], s76 offen lds
  s_waitcnt lgkmcnt(7)
  v_dot2c_f32_bf16 v48, s84, v128
  v_dot2c_f32_bf16 v49, v128, v128
  v_dot2c_f32_bf16 v48, s84, v129
  v_dot2c_f32_bf16 v49, v129, v129
  v_dot2c_f32_bf16 v48, s84, v130
  v_dot2c_f32_bf16 v49, v130, v130
  v_dot2c_f32_bf16 v48, s84, v131
  v_dot2c_f32_bf16 v49, v131, v131
  s_addk_i32 m0, 1024
  s_addk_i32 s76, 8192
  buffer_load_dwordx4 v28, s[12:15], s76 offen lds
  s_waitcnt lgkmcnt(6)
  v_dot2c_f32_bf16 v48, s84, v132
  v_dot2c_f32_bf16 v49, v132, v132
  v_dot2c_f32_bf16 v48, s84, v133
  v_dot2c_f32_bf16 v49, v133, v133
  v_dot2c_f32_bf16 v48, s84, v134
  v_dot2c_f32_bf16 v49, v134, v134
  v_dot2c_f32_bf16 v48, s84, v135
  v_dot2c_f32_bf16 v49, v135, v135
  s_addk_i32 m0, 1024
  s_addk_i32 s76, 8192
  buffer_load_dwordx4 v28, s[12:15], s76 offen lds
  s_waitcnt lgkmcnt(5)
  v_dot2c_f32_bf16 v48, s84, v136
  v_dot2c_f32_bf16 v49, v136, v136
  v_dot2c_f32_bf16 v48, s84, v137
  v_dot2c_f32_bf16 v49, v137, v137
  v_dot2c_f32_bf16 v48, s84, v138
  v_dot2c_f32_bf16 v49, v138, v138
  v_dot2c_f32_bf16 v48, s84, v139
  v_dot2c_f32_bf16 v49, v139, v139
  s_addk_i32 m0, 1024
  s_addk_i32 s76, 8192
  buffer_load_dwordx4 v28, s[12:15], s76 offen lds
  s_waitcnt lgkmcnt(4)
  v_dot2c_f32_bf16 v48, s84, v140
  v_dot2c_f32_bf16 v49, v140, v140
  v_dot2c_f32_bf16 v48, s84, v141
  v_dot2c_f32_bf16 v49, v141, v141
  v_dot2c_f32_bf16 v48, s84, v142
  v_dot2c_f32_bf16 v49, v142, v142
  v_dot2c_f32_bf16 v48, s84, v143
  v_dot2c_f32_bf16 v49, v143, v143
  s_addk_i32 m0, 1024
  s_addk_i32 s76, 8192
  buffer_load_dwordx4 v28, s[12:15], s76 offen lds
  s_waitcnt lgkmcnt(3)
  v_dot2c_f32_bf16 v48, s84, v144
  v_dot2c_f32_bf16 v49, v144, v144
  v_dot2c_f32_bf16 v48, s84, v145
  v_dot2c_f32_bf16 v49, v145, v145
  v_dot2c_f32_bf16 v48, s84, v146
  v_dot2c_f32_bf16 v49, v146, v146
  v_dot2c_f32_bf16 v48, s84, v147
  v_dot2c_f32_bf16 v49, v147, v147
  s_addk_i32 m0, 1024
  s_addk_i32 s76, 8192
  buffer_load_dwordx4 v28, s[12:15], s76 offen lds
  s_waitcnt lgkmcnt(2)
  v_dot2c_f32_bf16 v48, s84, v148
  v_dot2c_f32_bf16 v49, v148, v148
  v_dot2c_f32_bf16 v48, s84, v149
  v_dot2c_f32_bf16 v49, v149, v149
  v_dot2c_f32_bf16 v48, s84, v150
  v_dot2c_f32_bf16 v49, v150, v150
  v_dot2c_f32_bf16 v48, s84, v151
  v_dot2c_f32_bf16 v49, v151, v151
  s_addk_i32 m0, 1024
  s_addk_i32 s76, 8192
  buffer_load_dwordx4 v28, s[12:15], s76 offen lds
  s_waitcnt lgkmcnt(1)
  v_dot2c_f32_bf16 v48, s84, v152
  v_dot2c_f32_bf16 v49, v152, v152
  v_dot2c_f32_bf16 v48, s84, v153
  v_dot2c_f32_bf16 v49, v153, v153
  v_dot2c_f32_bf16 v48, s84, v154
  v_dot2c_f32_bf16 v49, v154, v154
  v_dot2c_f32_bf16 v48, s84, v155
  v_dot2c_f32_bf16 v49, v155, v155
  s_addk_i32 m0, 1024
  s_addk_i32 s76, 8192
  buffer_load_dwordx4 v28, s[12:15], s76 offen lds
  s_waitcnt lgkmcnt(0)
  v_dot2c_f32_bf16 v48, s84, v156
  v_dot2c_f32_bf16 v49, v156, v156
  v_dot2c_f32_bf16 v48, s84, v157
  v_dot2c_f32_bf16 v49, v157, v157
  v_dot2c_f32_bf16 v48, s84, v158
  v_dot2c_f32_bf16 v49, v158, v158
  v_dot2c_f32_bf16 v48, s84, v159
  v_dot2c_f32_bf16 v49, v159, v159
  s_waitcnt vmcnt(10)
  s_mov_b64 exec, 1
  ds_add_u32 v1, v2 offset:30028
  s_mov_b64 exec, -1
  ds_read_b128 v[64:67], v64
  ds_read_b128 v[68:71], v68
  ds_read_b128 v[72:75], v72
  ds_read_b128 v[76:79], v76
  ds_read_b128 v[80:83], v80
  ds_read_b128 v[84:87], v84
  ds_read_b128 v[88:91], v88
  ds_read_b128 v[92:95], v92
  s_addk_i32 m0, 1024
  s_addk_i32 s76, 8192
  buffer_load_dwordx4 v28, s[12:15], s76 offen lds
  s_waitcnt lgkmcnt(7)
  v_dot2c_f32_bf16 v50, s84, v64
  v_dot2c_f32_bf16 v51, v64, v64
  v_dot2c_f32_bf16 v50, s84, v65
  v_dot2c_f32_bf16 v51, v65, v65
  v_dot2c_f32_bf16 v50, s84, v66
  v_dot2c_f32_bf16 v51, v66, v66
  v_dot2c_f32_bf16 v50, s84, v67
  v_dot2c_f32_bf16 v51, v67, v67
  s_addk_i32 m0, 1024
  s_addk_i32 s76, 8192
  buffer_load_dwordx4 v28, s[12:15], s76 offen lds
  s_waitcnt lgkmcnt(6)
  v_dot2c_f32_bf16 v50, s84, v68
  v_dot2c_f32_bf16 v51, v68, v68
  v_dot2c_f32_bf16 v50, s84, v69
  v_dot2c_f32_bf16 v51, v69, v69
  v_dot2c_f32_bf16 v50, s84, v70
  v_dot2c_f32_bf16 v51, v70, v70
  v_dot2c_f32_bf16 v50, s84, v71
  v_dot2c_f32_bf16 v51, v71, v71
  s_addk_i32 m0, 1024
  s_addk_i32 s76, 8192
  buffer_load_dwordx4 v28, s[12:15], s76 offen lds
  s_waitcnt lgkmcnt(5)
  v_dot2c_f32_bf16 v50, s84, v72
  v_dot2c_f32_bf16 v51, v72, v72
  v_dot2c_f32_bf16 v50, s84, v73
  v_dot2c_f32_bf16 v51, v73, v73
  v_dot2c_f32_bf16 v50, s84, v74
  v_dot2c_f32_bf16 v51, v74, v74
  v_dot2c_f32_bf16 v50, s84, v75
  v_dot2c_f32_bf16 v51, v75, v75
  s_addk_i32 m0, 1024
  s_addk_i32 s76, 8192
  buffer_load_dwordx4 v28, s[12:15], s76 offen lds
  s_waitcnt lgkmcnt(4)
  v_dot2c_f32_bf16 v50, s84, v76
  v_dot2c_f32_bf16 v51, v76, v76
  v_dot2c_f32_bf16 v50, s84, v77
  v_dot2c_f32_bf16 v51, v77, v77
  v_dot2c_f32_bf16 v50, s84, v78
  v_dot2c_f32_bf16 v51, v78, v78
  v_dot2c_f32_bf16 v50, s84, v79
  v_dot2c_f32_bf16 v51, v79, v79
  s_addk_i32 m0, 1024
  s_addk_i32 s76, 8192
  buffer_load_dwordx4 v28, s[12:15], s76 offen lds
  s_waitcnt lgkmcnt(3)
  v_dot2c_f32_bf16 v50, s84, v80
  v_dot2c_f32_bf16 v51, v80, v80
  v_dot2c_f32_bf16 v50, s84, v81
  v_dot2c_f32_bf16 v51, v81, v81
  v_dot2c_f32_bf16 v50, s84, v82
  v_dot2c_f32_bf16 v51, v82, v82
  v_dot2c_f32_bf16 v50, s84, v83
  v_dot2c_f32_bf16 v51, v83, v83
  ds_read_b32 v7, v1 offset:30028
  s_addk_i32 m0, 1024
  s_addk_i32 s76, 8192
  buffer_load_dwordx4 v28, s[12:15], s76 offen lds
  s_waitcnt lgkmcnt(3)
  v_dot2c_f32_bf16 v50, s84, v84
  v_dot2c_f32_bf16 v51, v84, v84
  v_dot2c_f32_bf16 v50, s84, v85
  v_dot2c_f32_bf16 v51, v85, v85
  v_dot2c_f32_bf16 v50, s84, v86
  v_dot2c_f32_bf16 v51, v86, v86
  v_dot2c_f32_bf16 v50, s84, v87
  v_dot2c_f32_bf16 v51, v87, v87
  s_addk_i32 m0, 1024
  s_addk_i32 s76, 8192
  buffer_load_dwordx4 v28, s[12:15], s76 offen lds
  s_waitcnt lgkmcnt(2)
  v_dot2c_f32_bf16 v50, s84, v88
  v_dot2c_f32_bf16 v51, v88, v88
  v_dot2c_f32_bf16 v50, s84, v89
  v_dot2c_f32_bf16 v51, v89, v89
  v_dot2c_f32_bf16 v50, s84, v90
  v_dot2c_f32_bf16 v51, v90, v90
  v_dot2c_f32_bf16 v50, s84, v91
  v_dot2c_f32_bf16 v51, v91, v91
  s_addk_i32 m0, 1024
  s_addk_i32 s76, 8192
  buffer_load_dwordx4 v28, s[12:15], s76 offen lds
  s_waitcnt lgkmcnt(1)
  v_dot2c_f32_bf16 v50, s84, v92
  v_dot2c_f32_bf16 v51, v92, v92
  v_dot2c_f32_bf16 v50, s84, v93
  v_dot2c_f32_bf16 v51, v93, v93
  v_dot2c_f32_bf16 v50, s84, v94
  v_dot2c_f32_bf16 v51, v94, v94
  v_dot2c_f32_bf16 v50, s84, v95
  v_dot2c_f32_bf16 v51, v95, v95
  s_branch TH_2
TH_1:
  s_waitcnt vmcnt(10)
  ds_read_b128 v[64:67], v64
  ds_read_b128 v[68:71], v68
  ds_read_b128 v[72:75], v72
  ds_read_b128 v[76:79], v76
  ds_read_b128 v[80:83], v80
  ds_read_b128 v[84:87], v84
  ds_read_b128 v[88:91], v88
  ds_read_b128 v[92:95], v92
  s_add_u32 m0, s75, 32768
  s_nop 0
  buffer_load_dwordx4 v28, s[12:15], s76 offen lds
  s_waitcnt lgkmcnt(7)
  v_dot2c_f32_bf16 v50, s84, v64
  v_dot2c_f32_bf16 v51, v64, v64
  v_dot2c_f32_bf16 v50, s84, v65
  v_dot2c_f32_bf16 v51, v65, v65
  v_dot2c_f32_bf16 v50, s84, v66
  v_dot2c_f32_bf16 v51, v66, v66
  v_dot2c_f32_bf16 v50, s84, v67
  v_dot2c_f32_bf16 v51, v67, v67
  s_addk_i32 m0, 1024
  s_addk_i32 s76, 8192
  buffer_load_dwordx4 v28, s[12:15], s76 offen lds
  s_waitcnt lgkmcnt(6)
  v_dot2c_f32_bf16 v50, s84, v68
  v_dot2c_f32_bf16 v51, v68, v68
  v_dot2c_f32_bf16 v50, s84, v69
  v_dot2c_f32_bf16 v51, v69, v69
  v_dot2c_f32_bf16 v50, s84, v70
  v_dot2c_f32_bf16 v51, v70, v70
  v_dot2c_f32_bf16 v50, s84, v71
  v_dot2c_f32_bf16 v51, v71, v71
  s_addk_i32 m0, 1024
  s_addk_i32 s76, 8192
  buffer_load_dwordx4 v28, s[12:15], s76 offen lds
  s_waitcnt lgkmcnt(5)
  v_dot2c_f32_bf16 v50, s84, v72
  v_dot2c_f32_bf16 v51, v72, v72
  v_dot2c_f32_bf16 v50, s84, v73
  v_dot2c_f32_bf16 v51, v73, v73
  v_dot2c_f32_bf16 v50, s84, v74
  v_dot2c_f32_bf16 v51, v74, v74
  v_dot2c_f32_bf16 v50, s84, v75
  v_dot2c_f32_bf16 v51, v75, v75
  s_addk_i32 m0, 1024
  s_addk_i32 s76, 8192
  buffer_load_dwordx4 v28, s[12:15], s76 offen lds
  s_waitcnt lgkmcnt(4)
  v_dot2c_f32_bf16 v50, s84, v76
  v_dot2c_f32_bf16 v51, v76, v76
  v_dot2c_f32_bf16 v50, s84, v77
  v_dot2c_f32_bf16 v51, v77, v77
  v_dot2c_f32_bf16 v50, s84, v78
  v_dot2c_f32_bf16 v51, v78, v78
  v_dot2c_f32_bf16 v50, s84, v79
  v_dot2c_f32_bf16 v51, v79, v79
  s_addk_i32 m0, 1024
  s_addk_i32 s76, 8192
  buffer_load_dwordx4 v28, s[12:15], s76 offen lds
  s_waitcnt lgkmcnt(3)
  v_dot2c_f32_bf16 v50, s84, v80
  v_dot2c_f32_bf16 v51, v80, v80
  v_dot2c_f32_bf16 v50, s84, v81
  v_dot2c_f32_bf16 v51, v81, v81
  v_dot2c_f32_bf16 v50, s84, v82
  v_dot2c_f32_bf16 v51, v82, v82
  v_dot2c_f32_bf16 v50, s84, v83
  v_dot2c_f32_bf16 v51, v83, v83
  s_addk_i32 m0, 1024
  s_addk_i32 s76, 8192
  buffer_load_dwordx4 v28, s[12:15], s76 offen lds
  s_waitcnt lgkmcnt(2)
  v_dot2c_f32_bf16 v50, s84, v84
  v_dot2c_f32_bf16 v51, v84, v84
  v_dot2c_f32_bf16 v50, s84, v85
  v_dot2c_f32_bf16 v51, v85, v85
  v_dot2c_f32_bf16 v50, s84, v86
  v_dot2c_f32_bf16 v51, v86, v86
  v_dot2c_f32_bf16 v50, s84, v87
  v_dot2c_f32_bf16 v51, v87, v87
  s_addk_i32 m0, 1024
  s_addk_i32 s76, 8192
  buffer_load_dwordx4 v28, s[12:15], s76 offen lds
  s_waitcnt lgkmcnt(1)
  v_dot2c_f32_bf16 v50, s84, v88
  v_dot2c_f32_bf16 v51, v88, v88
  v_dot2c_f32_bf16 v50, s84, v89
  v_dot2c_f32_bf16 v51, v89, v89
  v_dot2c_f32_bf16 v50, s84, v90
  v_dot2c_f32_bf16 v51, v90, v90
  v_dot2c_f32_bf16 v50, s84, v91
  v_dot2c_f32_bf16 v51, v91, v91
  s_addk_i32 m0, 1024
  s_addk_i32 s76, 8192
  buffer_load_dwordx4 v28, s[12:15], s76 offen lds
  s_waitcnt lgkmcnt(0)
  v_dot2c_f32_bf16 v50, s84, v92
  v_dot2c_f32_bf16 v51, v92, v92
  v_dot2c_f32_bf16 v50, s84, v93
  v_dot2c_f32_bf16 v51, v93, v93
  v_dot2c_f32_bf16 v50, s84, v94
  v_dot2c_f32_bf16 v51, v94, v94
  v_dot2c_f32_bf16 v50, s84, v95
  v_dot2c_f32_bf16 v51, v95, v95
  s_waitcnt vmcnt(10)
  s_mov_b64 exec, 1
  ds_add_u32 v1, v2 offset:30028
  s_mov_b64 exec, -1
  ds_read_b128 v[128:131], v128
  ds_read_b128 v[132:135], v132
  ds_read_b128 v[136:139], v136
  ds_read_b128 v[140:143], v140
  ds_read_b128 v[144:147], v144
  ds_read_b128 v[148:151], v148
  ds_read_b128 v[152:155], v152
  ds_read_b128 v[156:159], v156
  s_addk_i32 m0, 1024
  s_addk_i32 s76, 8192
  buffer_load_dwordx4 v28, s[12:15], s76 offen lds
  s_waitcnt lgkmcnt(7)
  v_dot2c_f32_bf16 v48, s84, v128
  v_dot2c_f32_bf16 v49, v128, v128
  v_dot2c_f32_bf16 v48, s84, v129
  v_dot2c_f32_bf16 v49, v129, v129
  v_dot2c_f32_bf16 v48, s84, v130
  v_dot2c_f32_bf16 v49, v130, v130
  v_dot2c_f32_bf16 v48, s84, v131
  v_dot2c_f32_bf16 v49, v131, v131
  s_addk_i32 m0, 1024
  s_addk_i32 s76, 8192
  buffer_load_dwordx4 v28, s[12:15], s76 offen lds
  s_waitcnt lgkmcnt(6)
  v_dot2c_f32_bf16 v48, s84, v132
  v_dot2c_f32_bf16 v49, v132, v132
  v_dot2c_f32_bf16 v48, s84, v133
  v_dot2c_f32_bf16 v49, v133, v133
  v_dot2c_f32_bf16 v48, s84, v134
  v_dot2c_f32_bf16 v49, v134, v134
  v_dot2c_f32_bf16 v48, s84, v135
  v_dot2c_f32_bf16 v49, v135, v135
  s_addk_i32 m0, 1024
  s_addk_i32 s76, 8192
  buffer_load_dwordx4 v28, s[12:15], s76 offen lds
  s_waitcnt lgkmcnt(5)
  v_dot2c_f32_bf16 v48, s84, v136
  v_dot2c_f32_bf16 v49, v136, v136
  v_dot2c_f32_bf16 v48, s84, v137
  v_dot2c_f32_bf16 v49, v137, v137
  v_dot2c_f32_bf16 v48, s84, v138
  v_dot2c_f32_bf16 v49, v138, v138
  v_dot2c_f32_bf16 v48, s84, v139
  v_dot2c_f32_bf16 v49, v139, v139
  s_addk_i32 m0, 1024
  s_addk_i32 s76, 8192
  buffer_load_dwordx4 v28, s[12:15], s76 offen lds
  s_waitcnt lgkmcnt(4)
  v_dot2c_f32_bf16 v48, s84, v140
  v_dot2c_f32_bf16 v49, v140, v140
  v_dot2c_f32_bf16 v48, s84, v141
  v_dot2c_f32_bf16 v49, v141, v141
  v_dot2c_f32_bf16 v48, s84, v142
  v_dot2c_f32_bf16 v49, v142, v142
  v_dot2c_f32_bf16 v48, s84, v143
  v_dot2c_f32_bf16 v49, v143, v143
  s_addk_i32 m0, 1024
  s_addk_i32 s76, 8192
  buffer_load_dwordx4 v28, s[12:15], s76 offen lds
  s_waitcnt lgkmcnt(3)
  v_dot2c_f32_bf16 v48, s84, v144
  v_dot2c_f32_bf16 v49, v144, v144
  v_dot2c_f32_bf16 v48, s84, v145
  v_dot2c_f32_bf16 v49, v145, v145
  v_dot2c_f32_bf16 v48, s84, v146
  v_dot2c_f32_bf16 v49, v146, v146
  v_dot2c_f32_bf16 v48, s84, v147
  v_dot2c_f32_bf16 v49, v147, v147
  ds_read_b32 v7, v1 offset:30028
  s_addk_i32 m0, 1024
  s_addk_i32 s76, 8192
  buffer_load_dwordx4 v28, s[12:15], s76 offen lds
  s_waitcnt lgkmcnt(3)
  v_dot2c_f32_bf16 v48, s84, v148
  v_dot2c_f32_bf16 v49, v148, v148
  v_dot2c_f32_bf16 v48, s84, v149
  v_dot2c_f32_bf16 v49, v149, v149
  v_dot2c_f32_bf16 v48, s84, v150
  v_dot2c_f32_bf16 v49, v150, v150
  v_dot2c_f32_bf16 v48, s84, v151
  v_dot2c_f32_bf16 v49, v151, v151
  s_addk_i32 m0, 1024
  s_addk_i32 s76, 8192
  buffer_load_dwordx4 v28, s[12:15], s76 offen lds
  s_waitcnt lgkmcnt(2)
  v_dot2c_f32_bf16 v48, s84, v152
  v_dot2c_f32_bf16 v49, v152, v152
  v_dot2c_f32_bf16 v48, s84, v153
  v_dot2c_f32_bf16 v49, v153, v153
  v_dot2c_f32_bf16 v48, s84, v154
  v_dot2c_f32_bf16 v49, v154, v154
  v_dot2c_f32_bf16 v48, s84, v155
  v_dot2c_f32_bf16 v49, v155, v155
  s_addk_i32 m0, 1024
  s_addk_i32 s76, 8192
  buffer_load_dwordx4 v28, s[12:15], s76 offen lds
  s_waitcnt lgkmcnt(1)
  v_dot2c_f32_bf16 v48, s84, v156
  v_dot2c_f32_bf16 v49, v156, v156
  v_dot2c_f32_bf16 v48, s84, v157
  v_dot2c_f32_bf16 v49, v157, v157
  v_dot2c_f32_bf16 v48, s84, v158
  v_dot2c_f32_bf16 v49, v158, v158
  v_dot2c_f32_bf16 v48, s84, v159
  v_dot2c_f32_bf16 v49, v159, v159
TH_2:
  s_nop 2
  s_waitcnt lgkmcnt(0)
  v_readfirstlane_b32 s78, v7
  s_nop 0
  s_cmp_ge_u32 s78, 4
  s_cbranch_scc1 OK_3
  s_mov_b32 s79, 1000000
SP_4:
  ds_read_b32 v3, v1 offset:30028
  s_waitcnt lgkmcnt(0)
  v_readfirstlane_b32 s78, v3
  s_nop 0
  s_cmp_ge_u32 s78, 4
  s_cbranch_scc1 SPE_5
  s_sub_u32 s79, s79, 1
  s_cbranch_scc0 SP_4
SPE_5:
OK_3:
  ds_read_b128 v[160:163], v160
  ds_read_b128 v[164:167], v164
  ds_read_b128 v[168:171], v168
  ds_read_b128 v[172:175], v172
  ds_read_b128 v[192:195], v192
  ds_read_b128 v[196:199], v196
  ds_read_b128 v[200:203], v200
  ds_read_b128 v[204:207], v204
  v_permlane32_swap_b32 v48, v49
  v_permlane32_swap_b32 v50, v51
  v_add_f32 v48, v48, v49
  v_add_f32 v50, v50, v51
  ds_write_b32 v30, v48 offset:24832
  ds_write_b32 v16, v50 offset:24832
  s_waitcnt vmcnt(16)
  s_mov_b64 exec, 1
  ds_add_u32 v1, v2 offset:30016
  s_mov_b64 exec, -1
  ds_read_b128 v[224:227], v224
  ds_read_b128 v[228:231], v228
  ds_read_b128 v[232:235], v232
  ds_read_b128 v[236:239], v236
  ds_read_b128 v[176:179], v176
  ds_read_b128 v[180:183], v180
  ds_read_b128 v[184:187], v184
  ds_read_b128 v[188:191], v188
  ds_read_b128 v[208:211], v208
  ds_read_b128 v[212:215], v212
  ds_read_b128 v[216:219], v216
  ds_read_b128 v[220:223], v220
  ds_read_b128 v[240:243], v240
  ds_read_b128 v[244:247], v244
  ds_read_b128 v[248:251], v248
  ds_read_b128 v[252:255], v252
  s_waitcnt vmcnt(8)
  s_mov_b64 exec, 1
  ds_add_u32 v1, v2 offset:30040
  s_mov_b64 exec, -1
  s_mov_b32 s79, 1000000
SP_6:
  ds_read_b32 v3, v1 offset:30040
  s_waitcnt lgkmcnt(0)
  v_readfirstlane_b32 s78, v3
  s_nop 0
  s_cmp_ge_u32 s78, 4
  s_cbranch_scc1 SPE_7
  s_sub_u32 s79, s79, 1
  s_cbranch_scc0 SP_6
SPE_7:
  ds_read_b64_tr_b16 v[64:65], v24 offset:32768
  ds_read_b64_tr_b16 v[66:67], v24 offset:33280
  ds_read_b64_tr_b16 v[68:69], v24 offset:34816
  ds_read_b64_tr_b16 v[70:71], v24 offset:35328
  ds_read_b64_tr_b16 v[72:73], v24 offset:36864
  ds_read_b64_tr_b16 v[74:75], v24 offset:37376
  ds_read_b64_tr_b16 v[76:77], v24 offset:38912
  ds_read_b64_tr_b16 v[78:79], v24 offset:39424
  ds_read_b64_tr_b16 v[80:81], v25 offset:32768
  ds_read_b64_tr_b16 v[82:83], v25 offset:33280
  ds_read_b64_tr_b16 v[84:85], v25 offset:34816
  ds_read_b64_tr_b16 v[86:87], v25 offset:35328
  ds_read_b64_tr_b16 v[88:89], v25 offset:36864
  ds_read_b64_tr_b16 v[90:91], v25 offset:37376
  s_waitcnt lgkmcnt(12)
  v_mfma_f32_32x32x16_bf16 v[112:127], v[60:63], v[64:67], 0
  v_mfma_f32_32x32x16_bf16 v[96:111], v[64:67], v[128:131], 0
  ds_read2_b32 v[8:9], v32 offset0:0 offset1:32
  ds_read2_b32 v[10:11], v32 offset0:64 offset1:96
  ds_read2_b32 v[12:13], v32 offset0:128 offset1:160
  ds_read2_b32 v[14:15], v32 offset0:192 offset1:224
  ds_read_b64_tr_b16 v[92:93], v25 offset:38912
  ds_read_b64_tr_b16 v[94:95], v25 offset:39424
  s_waitcnt lgkmcnt(15)
  v_mfma_f32_32x32x16_bf16 v[112:127], v[60:63], v[68:71], v[112:127]
  v_mfma_f32_32x32x16_bf16 v[96:111], v[68:71], v[132:135], v[96:111]
  ds_read_b64_tr_b16 v[64:65], v26 offset:32768
  ds_read_b64_tr_b16 v[66:67], v26 offset:33280
  s_waitcnt lgkmcnt(15)
  v_mfma_f32_32x32x16_bf16 v[112:127], v[60:63], v[72:75], v[112:127]
  v_mfma_f32_32x32x16_bf16 v[96:111], v[72:75], v[136:139], v[96:111]
  ds_read_b64_tr_b16 v[68:69], v26 offset:34816
  ds_read_b64_tr_b16 v[70:71], v26 offset:35328
  s_waitcnt lgkmcnt(15)
  v_mfma_f32_32x32x16_bf16 v[112:127], v[60:63], v[76:79], v[112:127]
  v_mfma_f32_32x32x16_bf16 v[96:111], v[76:79], v[140:143], v[96:111]
  ds_read_b64_tr_b16 v[72:73], v26 offset:36864
  ds_read_b64_tr_b16 v[74:75], v26 offset:37376
  s_waitcnt lgkmcnt(15)
  v_mfma_f32_32x32x16_bf16 v[112:127], v[60:63], v[80:83], v[112:127]
  v_mfma_f32_32x32x16_bf16 v[96:111], v[80:83], v[160:163], v[96:111]
  ds_read_b64_tr_b16 v[76:77], v26 offset:38912
  ds_read_b64_tr_b16 v[78:79], v26 offset:39424
  s_waitcnt lgkmcnt(15)
  v_mfma_f32_32x32x16_bf16 v[112:127], v[60:63], v[84:87], v[112:127]
  v_mfma_f32_32x32x16_bf16 v[96:111], v[84:87], v[164:167], v[96:111]
  s_waitcnt vmcnt(0)
  s_mov_b64 exec, 1
  ds_add_u32 v1, v2 offset:30044
  s_mov_b64 exec, -1
  ds_read_b64_tr_b16 v[80:81], v27 offset:32768
  ds_read_b64_tr_b16 v[82:83], v27 offset:33280
  s_waitcnt lgkmcnt(15)
  v_mfma_f32_32x32x16_bf16 v[112:127], v[60:63], v[88:91], v[112:127]
  v_mfma_f32_32x32x16_bf16 v[96:111], v[88:91], v[168:171], v[96:111]
  ds_read_b64_tr_b16 v[84:85], v27 offset:34816
  ds_read_b64_tr_b16 v[86:87], v27 offset:35328
  s_waitcnt lgkmcnt(13)
  v_mfma_f32_32x32x16_bf16 v[112:127], v[60:63], v[92:95], v[112:127]
  v_mfma_f32_32x32x16_bf16 v[96:111], v[92:95], v[172:175], v[96:111]
  ds_read_b32 v7, v1 offset:30044
  ds_read_b64_tr_b16 v[88:89], v27 offset:36864
  ds_read_b64_tr_b16 v[90:91], v27 offset:37376
  s_waitcnt lgkmcnt(14)
  v_mfma_f32_32x32x16_bf16 v[96:111], v[64:67], v[192:195], v[96:111]
  ds_read_b64_tr_b16 v[92:93], v27 offset:38912
  ds_read_b64_tr_b16 v[94:95], v27 offset:39424
  s_waitcnt lgkmcnt(14)
  v_mfma_f32_32x32x16_bf16 v[96:111], v[68:71], v[196:199], v[96:111]
  s_waitcnt lgkmcnt(4)
  v_readfirstlane_b32 s78, v7
  s_nop 0
  s_cmp_ge_u32 s78, 4
  s_cbranch_scc1 OK_8
  s_mov_b32 s79, 1000000
SP_9:
  ds_read_b32 v3, v1 offset:30044
  s_waitcnt lgkmcnt(0)
  v_readfirstlane_b32 s78, v3
  s_nop 0
  s_cmp_ge_u32 s78, 4
  s_cbranch_scc1 SPE_10
  s_sub_u32 s79, s79, 1
  s_cbranch_scc0 SP_9
SPE_10:
OK_8:
  ds_read_b64_tr_b16 v[64:65], v24 offset:40960
  ds_read_b64_tr_b16 v[66:67], v24 offset:41472
  v_mfma_f32_32x32x16_bf16 v[96:111], v[72:75], v[200:203], v[96:111]
  ds_read_b64_tr_b16 v[68:69], v24 offset:43008
  ds_read_b64_tr_b16 v[70:71], v24 offset:43520
  v_mfma_f32_32x32x16_bf16 v[96:111], v[76:79], v[204:207], v[96:111]
  v_add_f32 v8, v8, v12
  v_add_f32 v9, v9, v13
  ds_read_b64_tr_b16 v[72:73], v24 offset:45056
  ds_read_b64_tr_b16 v[74:75], v24 offset:45568
  v_mfma_f32_32x32x16_bf16 v[96:111], v[80:83], v[224:227], v[96:111]
  v_add_f32 v10, v10, v14
  v_add_f32 v11, v11, v15
  ds_read_b64_tr_b16 v[76:77], v24 offset:47104
  ds_read_b64_tr_b16 v[78:79], v24 offset:47616
  v_mfma_f32_32x32x16_bf16 v[96:111], v[84:87], v[228:231], v[96:111]
  v_add_f32 v52, v8, v10
  v_add_f32 v53, v9, v11
  ds_read_b64_tr_b16 v[80:81], v25 offset:40960
  ds_read_b64_tr_b16 v[82:83], v25 offset:41472
  s_waitcnt lgkmcnt(12)
  v_mfma_f32_32x32x16_bf16 v[96:111], v[88:91], v[232:235], v[96:111]
  v_mul_f32 v52, 0x3b000000, v52
  v_mul_f32 v53, 0x3b000000, v53
  ds_read_b64_tr_b16 v[84:85], v25 offset:43008
  ds_read_b64_tr_b16 v[86:87], v25 offset:43520
  s_waitcnt lgkmcnt(12)
  v_mfma_f32_32x32x16_bf16 v[96:111], v[92:95], v[236:239], v[96:111]
  v_fma_f32 v53, -v52, v52, v53
  v_max_f32 v53, 0, v53
  ds_read_b64_tr_b16 v[88:89], v25 offset:45056
  ds_read_b64_tr_b16 v[90:91], v25 offset:45568
  s_waitcnt lgkmcnt(12)
  v_mfma_f32_32x32x16_bf16 v[112:127], v[60:63], v[64:67], v[112:127]
  v_mfma_f32_32x32x16_bf16 v[96:111], v[64:67], v[144:147], v[96:111]
  v_add_f32 v53, 0x3727c5ac, v53
  v_rsq_f32 v53, v53
  ds_read_b64_tr_b16 v[92:93], v25 offset:47104
  ds_read_b64_tr_b16 v[94:95], v25 offset:47616
  s_waitcnt lgkmcnt(12)
  v_mfma_f32_32x32x16_bf16 v[112:127], v[60:63], v[68:71], v[112:127]
  v_mfma_f32_32x32x16_bf16 v[96:111], v[68:71], v[148:151], v[96:111]
  v_mul_f32 v8, v53, v53
  v_mov_b32 v9, 0x3f800054
  ds_read_b64_tr_b16 v[64:65], v26 offset:40960
  ds_read_b64_tr_b16 v[66:67], v26 offset:41472
  s_waitcnt lgkmcnt(12)
  v_mfma_f32_32x32x16_bf16 v[112:127], v[60:63], v[72:75], v[112:127]
  v_mfma_f32_32x32x16_bf16 v[96:111], v[72:75], v[152:155], v[96:111]
  v_fmac_f32 v9, 0xb727c5ac, v8
  v_rsq_f32 v9, v9
  ds_read_b64_tr_b16 v[68:69], v26 offset:43008
  ds_read_b64_tr_b16 v[70:71], v26 offset:43520
  s_waitcnt lgkmcnt(12)
  v_mfma_f32_32x32x16_bf16 v[112:127], v[60:63], v[76:79], v[112:127]
  v_mfma_f32_32x32x16_bf16 v[96:111], v[76:79], v[156:159], v[96:111]
  v_mul_f32 v53, s82, v53
  v_mul_f32 v53, v53, v9
  s_mov_b64 exec, 0xff
  buffer_load_dword v54, v29, s[28:31], s25 offen offset:768 sc1
  s_mov_b64 exec, -1
  ds_read_b64_tr_b16 v[72:73], v26 offset:45056
  ds_read_b64_tr_b16 v[74:75], v26 offset:45568
  s_waitcnt lgkmcnt(12)
  v_mfma_f32_32x32x16_bf16 v[112:127], v[60:63], v[80:83], v[112:127]
  v_mfma_f32_32x32x16_bf16 v[96:111], v[80:83], v[176:179], v[96:111]
  s_add_u32 s68, s68, 1
  s_mov_b32 s69, s68
  ds_read_b64_tr_b16 v[76:77], v26 offset:47104
  ds_read_b64_tr_b16 v[78:79], v26 offset:47616
  s_waitcnt lgkmcnt(12)
  v_mfma_f32_32x32x16_bf16 v[112:127], v[60:63], v[84:87], v[112:127]
  v_mfma_f32_32x32x16_bf16 v[96:111], v[84:87], v[180:183], v[96:111]
  s_getreg_b32 s38, hwreg(HW_REG_XCC_ID, 0, 4)
  s_lshl_b32 s38, s38, 28
  ds_read_b64_tr_b16 v[80:81], v27 offset:40960
  ds_read_b64_tr_b16 v[82:83], v27 offset:41472
  s_waitcnt lgkmcnt(12)
  v_mfma_f32_32x32x16_bf16 v[112:127], v[60:63], v[88:91], v[112:127]
  v_mfma_f32_32x32x16_bf16 v[96:111], v[88:91], v[184:187], v[96:111]
  s_add_u32 s38, s38, s68
  ds_read_b64_tr_b16 v[84:85], v27 offset:43008
  ds_read_b64_tr_b16 v[86:87], v27 offset:43520
  s_waitcnt lgkmcnt(12)
  v_mfma_f32_32x32x16_bf16 v[112:127], v[60:63], v[92:95], v[112:127]
  v_mfma_f32_32x32x16_bf16 v[96:111], v[92:95], v[188:191], v[96:111]
  ds_read_b64_tr_b16 v[88:89], v27 offset:45056
  ds_read_b64_tr_b16 v[90:91], v27 offset:45568
  s_waitcnt lgkmcnt(12)
  v_mfma_f32_32x32x16_bf16 v[96:111], v[64:67], v[208:211], v[96:111]
  ds_read_b64_tr_b16 v[92:93], v27 offset:47104
  ds_read_b64_tr_b16 v[94:95], v27 offset:47616
  s_waitcnt lgkmcnt(12)
  v_mfma_f32_32x32x16_bf16 v[96:111], v[68:71], v[212:215], v[96:111]
  s_waitcnt lgkmcnt(10)
  v_mfma_f32_32x32x16_bf16 v[96:111], v[72:75], v[216:219], v[96:111]
  s_nop 0
  ds_write_b32 v31, v112 offset:26880
  s_mov_b64 exec, 1
  ds_add_u32 v1, v2 offset:30056
  s_mov_b64 exec, -1
  s_waitcnt lgkmcnt(10)
  v_mfma_f32_32x32x16_bf16 v[96:111], v[76:79], v[220:223], v[96:111]
  s_waitcnt lgkmcnt(8)
  v_mfma_f32_32x32x16_bf16 v[96:111], v[80:83], v[240:243], v[96:111]
  s_waitcnt lgkmcnt(6)
  v_mfma_f32_32x32x16_bf16 v[96:111], v[84:87], v[244:247], v[96:111]
  ds_read_b32 v7, v1 offset:30056
  s_waitcnt lgkmcnt(5)
  v_mfma_f32_32x32x16_bf16 v[96:111], v[88:91], v[248:251], v[96:111]
  s_waitcnt lgkmcnt(3)
  v_mfma_f32_32x32x16_bf16 v[96:111], v[92:95], v[252:255], v[96:111]
  s_waitcnt lgkmcnt(0)
  v_readfirstlane_b32 s78, v7
  s_nop 0
  s_cmp_ge_u32 s78, 4
  s_cbranch_scc1 OK_11
  s_mov_b32 s79, 1000000
SP_12:
  ds_read_b32 v3, v1 offset:30056
  s_waitcnt lgkmcnt(0)
  v_readfirstlane_b32 s78, v3
  s_nop 0
  s_cmp_ge_u32 s78, 4
  s_cbranch_scc1 SPE_13
  s_sub_u32 s79, s79, 1
  s_cbranch_scc0 SP_12
SPE_13:
OK_11:
  ds_read_b128 v[128:131], v33 offset:26880
  ds_read_b128 v[144:147], v33 offset:27392
  ds_read_b128 v[132:135], v33 offset:26912
  ds_read_b128 v[148:151], v33 offset:27424
  ds_read_b128 v[136:139], v33 offset:26944
  ds_read_b128 v[152:155], v33 offset:27456
  ds_read_b128 v[140:143], v33 offset:26976
  ds_read_b128 v[156:159], v33 offset:27488
  s_waitcnt lgkmcnt(4)
  v_pk_add_f32 v[128:129], v[128:129], v[144:145]
  v_pk_add_f32 v[130:131], v[130:131], v[146:147]
  v_pk_add_f32 v[132:133], v[132:133], v[148:149]
  v_pk_add_f32 v[134:135], v[134:135], v[150:151]
  v_pk_fma_f32 v[96:97], v[128:129], v[52:53], v[96:97] op_sel_hi:[1,0,1] neg_lo:[0,1,0] neg_hi:[0,1,0]
  v_pk_fma_f32 v[98:99], v[130:131], v[52:53], v[98:99] op_sel_hi:[1,0,1] neg_lo:[0,1,0] neg_hi:[0,1,0]
  v_pk_fma_f32 v[100:101], v[132:133], v[52:53], v[100:101] op_sel_hi:[1,0,1] neg_lo:[0,1,0] neg_hi:[0,1,0]
  v_pk_fma_f32 v[102:103], v[134:135], v[52:53], v[102:103] op_sel_hi:[1,0,1] neg_lo:[0,1,0] neg_hi:[0,1,0]
  v_pk_mul_f32 v[96:97], v[52:53], v[96:97] op_sel:[1,0] op_sel_hi:[1,1]
  v_pk_mul_f32 v[98:99], v[52:53], v[98:99] op_sel:[1,0] op_sel_hi:[1,1]
  v_pk_mul_f32 v[100:101], v[52:53], v[100:101] op_sel:[1,0] op_sel_hi:[1,1]
  v_pk_mul_f32 v[102:103], v[52:53], v[102:103] op_sel:[1,0] op_sel_hi:[1,1]
  v_pk_fma_f32 v[64:65], v[96:97], v[96:97], s[80:81]
  v_pk_fma_f32 v[66:67], v[98:99], v[98:99], s[80:81]
  v_pk_fma_f32 v[68:69], v[100:101], v[100:101], s[80:81]
  v_pk_fma_f32 v[70:71], v[102:103], v[102:103], s[80:81]
  v_pk_mul_f32 v[64:65], v[64:65], v[96:97]
  v_pk_mul_f32 v[66:67], v[66:67], v[98:99]
  v_pk_mul_f32 v[68:69], v[68:69], v[100:101]
  v_pk_mul_f32 v[70:71], v[70:71], v[102:103]
  v_exp_f32 v64, -v64
  v_exp_f32 v66, -v66
  v_exp_f32 v68, -v68
  v_exp_f32 v70, -v70
  v_exp_f32 v65, -v65
  v_exp_f32 v67, -v67
  v_exp_f32 v69, -v69
  v_exp_f32 v71, -v71
  v_pk_fma_f32 v[64:65], v[64:65], s[82:83], s[82:83]
  v_pk_fma_f32 v[66:67], v[66:67], s[82:83], s[82:83]
  v_pk_fma_f32 v[68:69], v[68:69], s[82:83], s[82:83]
  v_pk_fma_f32 v[70:71], v[70:71], s[82:83], s[82:83]
  v_rcp_f32 v64, v64
  v_rcp_f32 v66, v66
  v_rcp_f32 v68, v68
  v_rcp_f32 v70, v70
  v_rcp_f32 v65, v65
  v_rcp_f32 v67, v67
  v_rcp_f32 v69, v69
  v_rcp_f32 v71, v71
  v_pk_mul_f32 v[64:65], v[64:65], v[96:97]
  v_pk_mul_f32 v[66:67], v[66:67], v[98:99]
  v_pk_mul_f32 v[68:69], v[68:69], v[100:101]
  v_pk_mul_f32 v[70:71], v[70:71], v[102:103]
  v_cvt_pk_bf16_f32 v56, v64, v65
  v_cvt_pk_bf16_f32 v57, v66, v67
  v_cvt_pk_bf16_f32 v58, v68, v69
  v_cvt_pk_bf16_f32 v59, v70, v71
  buffer_store_dwordx4 v[56:59], v4, s[28:31], s47 offen offset:0 sc1
  s_waitcnt lgkmcnt(0)
  v_pk_add_f32 v[136:137], v[136:137], v[152:153]
  v_pk_add_f32 v[138:139], v[138:139], v[154:155]
  v_pk_add_f32 v[140:141], v[140:141], v[156:157]
  v_pk_add_f32 v[142:143], v[142:143], v[158:159]
  v_pk_fma_f32 v[104:105], v[136:137], v[52:53], v[104:105] op_sel_hi:[1,0,1] neg_lo:[0,1,0] neg_hi:[0,1,0]
  v_pk_fma_f32 v[106:107], v[138:139], v[52:53], v[106:107] op_sel_hi:[1,0,1] neg_lo:[0,1,0] neg_hi:[0,1,0]
  v_pk_fma_f32 v[108:109], v[140:141], v[52:53], v[108:109] op_sel_hi:[1,0,1] neg_lo:[0,1,0] neg_hi:[0,1,0]
  v_pk_fma_f32 v[110:111], v[142:143], v[52:53], v[110:111] op_sel_hi:[1,0,1] neg_lo:[0,1,0] neg_hi:[0,1,0]
  v_pk_mul_f32 v[104:105], v[52:53], v[104:105] op_sel:[1,0] op_sel_hi:[1,1]
  v_pk_mul_f32 v[106:107], v[52:53], v[106:107] op_sel:[1,0] op_sel_hi:[1,1]
  v_pk_mul_f32 v[108:109], v[52:53], v[108:109] op_sel:[1,0] op_sel_hi:[1,1]
  v_pk_mul_f32 v[110:111], v[52:53], v[110:111] op_sel:[1,0] op_sel_hi:[1,1]
  v_pk_fma_f32 v[64:65], v[104:105], v[104:105], s[80:81]
  v_pk_fma_f32 v[66:67], v[106:107], v[106:107], s[80:81]
  v_pk_fma_f32 v[68:69], v[108:109], v[108:109], s[80:81]
  v_pk_fma_f32 v[70:71], v[110:111], v[110:111], s[80:81]
  v_pk_mul_f32 v[64:65], v[64:65], v[104:105]
  v_pk_mul_f32 v[66:67], v[66:67], v[106:107]
  v_pk_mul_f32 v[68:69], v[68:69], v[108:109]
  v_pk_mul_f32 v[70:71], v[70:71], v[110:111]
  v_exp_f32 v64, -v64
  v_exp_f32 v66, -v66
  v_exp_f32 v68, -v68
  v_exp_f32 v70, -v70
  v_exp_f32 v65, -v65
  v_exp_f32 v67, -v67
  v_exp_f32 v69, -v69
  v_exp_f32 v71, -v71
  v_pk_fma_f32 v[64:65], v[64:65], s[82:83], s[82:83]
  v_pk_fma_f32 v[66:67], v[66:67], s[82:83], s[82:83]
  v_pk_fma_f32 v[68:69], v[68:69], s[82:83], s[82:83]
  v_pk_fma_f32 v[70:71], v[70:71], s[82:83], s[82:83]
  v_rcp_f32 v64, v64
  v_rcp_f32 v66, v66
  v_rcp_f32 v68, v68
  v_rcp_f32 v70, v70
  v_rcp_f32 v65, v65
  v_rcp_f32 v67, v67
  v_rcp_f32 v69, v69
  v_rcp_f32 v71, v71
  v_pk_mul_f32 v[64:65], v[64:65], v[104:105]
  v_pk_mul_f32 v[66:67], v[66:67], v[106:107]
  v_pk_mul_f32 v[68:69], v[68:69], v[108:109]
  v_pk_mul_f32 v[70:71], v[70:71], v[110:111]
  v_cvt_pk_bf16_f32 v60, v64, v65
  v_cvt_pk_bf16_f32 v61, v66, v67
  v_cvt_pk_bf16_f32 v62, v68, v69
  v_cvt_pk_bf16_f32 v63, v70, v71
  buffer_store_dwordx4 v[60:63], v4, s[28:31], s47 offen offset:1024 sc1
  s_waitcnt vmcnt(2)
  s_mov_b32 s79, 200000
  s_mov_b64 exec, 0xff
MD_14:
  v_subrev_u32 v8, s68, v54
  v_and_b32 v8, 0x0fffffff, v8
  v_cmp_ne_u32 vcc, 0, v8
  s_nop 4
  s_cbranch_vccz MD_15
  s_sleep 2
  buffer_load_dword v54, v29, s[28:31], s25 offen offset:768 sc1
  s_waitcnt vmcnt(0)
  s_sub_u32 s79, s79, 1
  s_cbranch_scc0 MD_14
MD_15:
  v_cmp_ne_u32 vcc, s38, v54
  s_nop 0
  s_cmp_eq_u64 vcc, 0
  s_cselect_b32 s24, 1, 2
  v_mov_b32 v8, s24
  s_mov_b64 exec, 1
  ds_write_b32 v1, v8 offset:30128
  s_mov_b64 exec, -1
  s_mov_b32 s79, 1000000
SP_16:
  ds_read_b32 v3, v1 offset:30064
  s_waitcnt lgkmcnt(0)
  v_readfirstlane_b32 s78, v3
  s_nop 0
  s_cmp_ge_u32 s78, 4
  s_cbranch_scc1 SPE_17
  s_sub_u32 s79, s79, 1
  s_cbranch_scc0 SP_16
SPE_17:
  ds_read_b64 v[8:9], v36 offset:16640
  ds_read_b64 v[10:11], v36 offset:16656
  ds_read_b64 v[12:13], v36 offset:16672
  ds_read_b64 v[14:15], v36 offset:16688
  ds_read_b64 v[50:51], v37 offset:27920
  ds_read_b64_tr_b16 v[128:129], v34 offset:0
  ds_read_b64_tr_b16 v[130:131], v34 offset:1024
  ds_read_b64_tr_b16 v[132:133], v34 offset:2048
  ds_read_b64_tr_b16 v[134:135], v34 offset:3072
  ds_read_b64_tr_b16 v[136:137], v34 offset:4096
  ds_read_b64_tr_b16 v[138:139], v34 offset:5120
  ds_read_b64_tr_b16 v[140:141], v34 offset:6144
  ds_read_b64_tr_b16 v[142:143], v34 offset:7168
  ds_read_b64_tr_b16 v[144:145], v35 offset:0
  ds_read_b64_tr_b16 v[146:147], v35 offset:1024
  ds_read_b64_tr_b16 v[148:149], v35 offset:2048
  ds_read_b64_tr_b16 v[150:151], v35 offset:3072
  ds_read_b64_tr_b16 v[152:153], v35 offset:4096
  ds_read_b64_tr_b16 v[154:155], v35 offset:5120
  ds_read_b64_tr_b16 v[156:157], v35 offset:6144
  ds_read_b64_tr_b16 v[158:159], v35 offset:7168
  ds_read_b64_tr_b16 v[160:161], v34 offset:16384
  ds_read_b64_tr_b16 v[162:163], v34 offset:17408
  ds_read_b64_tr_b16 v[164:165], v34 offset:18432
  ds_read_b64_tr_b16 v[166:167], v34 offset:19456
  ds_read_b64_tr_b16 v[168:169], v34 offset:20480
  ds_read_b64_tr_b16 v[170:171], v34 offset:21504
  ds_read_b64_tr_b16 v[172:173], v34 offset:22528
  ds_read_b64_tr_b16 v[174:175], v34 offset:23552
  ds_read_b64_tr_b16 v[176:177], v35 offset:16384
  ds_read_b64_tr_b16 v[178:179], v35 offset:17408
  ds_read_b64_tr_b16 v[180:181], v35 offset:18432
  ds_read_b64_tr_b16 v[182:183], v35 offset:19456
  ds_read_b64_tr_b16 v[184:185], v35 offset:20480
  ds_read_b64_tr_b16 v[186:187], v35 offset:21504
  ds_read_b64_tr_b16 v[188:189], v35 offset:22528
  ds_read_b64_tr_b16 v[190:191], v35 offset:23552
  ds_read_b64_tr_b16 v[192:193], v34 offset:32768
  ds_read_b64_tr_b16 v[194:195], v34 offset:33792
  ds_read_b64_tr_b16 v[196:197], v34 offset:34816
  ds_read_b64_tr_b16 v[198:199], v34 offset:35840
  ds_read_b64_tr_b16 v[200:201], v34 offset:36864
  ds_read_b64_tr_b16 v[202:203], v34 offset:37888
  ds_read_b64_tr_b16 v[204:205], v34 offset:38912
  ds_read_b64_tr_b16 v[206:207], v34 offset:39936
  ds_read_b64_tr_b16 v[208:209], v35 offset:32768
  ds_read_b64_tr_b16 v[210:211], v35 offset:33792
  ds_read_b64_tr_b16 v[212:213], v35 offset:34816
  ds_read_b64_tr_b16 v[214:215], v35 offset:35840
  ds_read_b64_tr_b16 v[216:217], v35 offset:36864
  ds_read_b64_tr_b16 v[218:219], v35 offset:37888
  ds_read_b64_tr_b16 v[220:221], v35 offset:38912
  ds_read_b64_tr_b16 v[222:223], v35 offset:39936
  s_waitcnt vmcnt(0)
  v_mov_b32 v3, s68
  s_mov_b64 exec, 1
  s_cmp_lg_u32 s24, 1
  s_cbranch_scc1 FS_18
  buffer_store_dword v3, off, s[28:31], s43 offset:0
  s_branch FE_19
FS_18:
  buffer_store_dword v3, off, s[28:31], s43 offset:0 sc1
FE_19:
  s_mov_b64 exec, -1
  ds_read_b64_tr_b16 v[224:225], v34 offset:49152
  ds_read_b64_tr_b16 v[226:227], v34 offset:50176
  ds_read_b64_tr_b16 v[228:229], v34 offset:51200
  ds_read_b64_tr_b16 v[230:231], v34 offset:52224
  ds_read_b64_tr_b16 v[232:233], v34 offset:53248
  ds_read_b64_tr_b16 v[234:235], v34 offset:54272
  ds_read_b64_tr_b16 v[236:237], v34 offset:55296
  ds_read_b64_tr_b16 v[238:239], v34 offset:56320
  ds_read_b64_tr_b16 v[240:241], v35 offset:49152
  ds_read_b64_tr_b16 v[242:243], v35 offset:50176
  ds_read_b64_tr_b16 v[244:245], v35 offset:51200
  ds_read_b64_tr_b16 v[246:247], v35 offset:52224
  ds_read_b64_tr_b16 v[248:249], v35 offset:53248
  ds_read_b64_tr_b16 v[250:251], v35 offset:54272
  ds_read_b64_tr_b16 v[252:253], v35 offset:55296
  ds_read_b64_tr_b16 v[254:255], v35 offset:56320
  s_mov_b64 exec, 1
  ds_add_u32 v1, v2 offset:30068
  s_mov_b64 exec, -1
  s_waitcnt lgkmcnt(15)
  v_lshlrev_b32 v96, 16, v8
  v_and_b32 v97, 0xffff0000, v8
  v_lshlrev_b32 v98, 16, v9
  v_and_b32 v99, 0xffff0000, v9
  v_lshlrev_b32 v100, 16, v10
  v_and_b32 v101, 0xffff0000, v10
  v_lshlrev_b32 v102, 16, v11
  v_and_b32 v103, 0xffff0000, v11
  v_lshlrev_b32 v104, 16, v12
  v_and_b32 v105, 0xffff0000, v12
  v_lshlrev_b32 v106, 16, v13
  v_and_b32 v107, 0xffff0000, v13
  v_lshlrev_b32 v108, 16, v14
  v_and_b32 v109, 0xffff0000, v14
  v_lshlrev_b32 v110, 16, v15
  v_and_b32 v111, 0xffff0000, v15
  v_sub_f32 v96, v96, v50
  v_sub_f32 v97, v97, v50
  v_sub_f32 v98, v98, v50
  v_sub_f32 v99, v99, v50
  v_sub_f32 v100, v100, v50
  v_sub_f32 v101, v101, v50
  v_sub_f32 v102, v102, v50
  v_sub_f32 v103, v103, v50
  v_sub_f32 v104, v104, v50
  v_sub_f32 v105, v105, v50
  v_sub_f32 v106, v106, v50
  v_sub_f32 v107, v107, v50
  v_sub_f32 v108, v108, v50
  v_sub_f32 v109, v109, v50
  v_sub_f32 v110, v110, v50
  v_sub_f32 v111, v111, v50
  v_mul_f32 v96, v96, v51
  v_mul_f32 v97, v97, v51
  v_mul_f32 v98, v98, v51
  v_mul_f32 v99, v99, v51
  v_mul_f32 v100, v100, v51
  v_mul_f32 v101, v101, v51
  v_mul_f32 v102, v102, v51
  v_mul_f32 v103, v103, v51
  v_mul_f32 v104, v104, v51
  v_mul_f32 v105, v105, v51
  v_mul_f32 v106, v106, v51
  v_mul_f32 v107, v107, v51
  v_mul_f32 v108, v108, v51
  v_mul_f32 v109, v109, v51
  v_mul_f32 v110, v110, v51
  v_mul_f32 v111, v111, v51
  s_mov_b32 s79, 200000
  s_mov_b64 exec, 0xff
PL_20:
  buffer_load_dword v48, v29, s[28:31], s44 offen offset:0 sc1
  s_waitcnt vmcnt(0)
  v_cmp_ne_u32 vcc, s68, v48
  s_nop 4
  s_cbranch_vccz PLE_21
  s_sub_u32 s79, s79, 1
  s_cbranch_scc0 PL_20
PLE_21:
  s_mov_b64 exec, -1
  s_cmp_eq_u32 s24, 1
  s_cbranch_scc1 PLF_22
  buffer_inv sc1
  s_waitcnt vmcnt(0)
PLF_22:
  s_add_u32 s46, s52, 4096
  s_add_u32 m0, s75, 32768
  s_nop 0
  buffer_load_dwordx4 v4, s[28:31], s52 offen offset:0 sc1 lds
  buffer_load_dwordx4 v4, s[28:31], s52 offen offset:1024 sc1 lds
  s_add_u32 m0, s75, 36864
  s_nop 0
  buffer_load_dwordx4 v4, s[28:31], s46 offen offset:0 sc1 lds
  buffer_load_dwordx4 v4, s[28:31], s46 offen offset:1024 sc1 lds
  s_add_u32 m0, s75, 32768
  s_nop 0
  buffer_load_dwordx4 v4, s[28:31], s52 offen offset:2048 sc1 lds
  buffer_load_dwordx4 v4, s[28:31], s52 offen offset:3072 sc1 lds
  s_add_u32 m0, s75, 36864
  s_nop 0
  buffer_load_dwordx4 v4, s[28:31], s46 offen offset:2048 sc1 lds
  buffer_load_dwordx4 v4, s[28:31], s46 offen offset:3072 sc1 lds
  s_xor_b32 s52, s52, 8192
  s_add_u32 s46, s52, 4096
  s_add_u32 m0, s75, 40960
  s_nop 0
  buffer_load_dwordx4 v4, s[28:31], s52 offen offset:0 sc1 lds
  buffer_load_dwordx4 v4, s[28:31], s52 offen offset:1024 sc1 lds
  s_add_u32 m0, s75, 45056
  s_nop 0
  buffer_load_dwordx4 v4, s[28:31], s46 offen offset:0 sc1 lds
  buffer_load_dwordx4 v4, s[28:31], s46 offen offset:1024 sc1 lds
  s_waitcnt vmcnt(8)
  s_mov_b64 exec, 1
  ds_add_u32 v1, v2 offset:30072
  s_mov_b64 exec, -1
  s_add_u32 m0, s75, 40960
  s_nop 0
  buffer_load_dwordx4 v4, s[28:31], s52 offen offset:2048 sc1 lds
  buffer_load_dwordx4 v4, s[28:31], s52 offen offset:3072 sc1 lds
  s_add_u32 m0, s75, 45056
  s_nop 0
  buffer_load_dwordx4 v4, s[28:31], s46 offen offset:2048 sc1 lds
  buffer_load_dwordx4 v4, s[28:31], s46 offen offset:3072 sc1 lds
  s_mov_b32 s79, 1000000
SP_23:
  ds_read_b32 v3, v1 offset:30072
  s_waitcnt lgkmcnt(0)
  v_readfirstlane_b32 s78, v3
  s_nop 0
  s_cmp_ge_u32 s78, 4
  s_cbranch_scc1 SPE_24
  s_sub_u32 s79, s79, 1
  s_cbranch_scc0 SP_23
SPE_24:
  ds_read_b128 v[64:67], v38 offset:0
  ds_read_b128 v[68:71], v38 offset:1024
  ds_read_b128 v[72:75], v38 offset:16384
  ds_read_b128 v[76:79], v38 offset:17408
  ds_read_b128 v[80:83], v38 offset:32768
  s_waitcnt vmcnt(8)
  s_mov_b64 exec, 1
  ds_add_u32 v1, v2 offset:30076
  s_mov_b64 exec, -1
  ds_read_b128 v[84:87], v38 offset:33792
  s_waitcnt lgkmcnt(6)
  v_mfma_f32_32x32x16_bf16 v[96:111], v[128:131], v[64:67], v[96:111]
  ds_read_b32 v7, v1 offset:30076
  ds_read_b128 v[88:91], v38 offset:49152
  s_waitcnt lgkmcnt(7)
  v_mfma_f32_32x32x16_bf16 v[96:111], v[132:135], v[68:71], v[96:111]
  ds_read_b128 v[92:95], v38 offset:50176
  s_waitcnt lgkmcnt(7)
  v_mfma_f32_32x32x16_bf16 v[96:111], v[160:163], v[72:75], v[96:111]
  s_waitcnt lgkmcnt(2)
  v_readfirstlane_b32 s78, v7
  s_nop 0
  s_cmp_ge_u32 s78, 4
  s_cbranch_scc1 OK_25
  s_mov_b32 s79, 1000000
SP_26:
  ds_read_b32 v3, v1 offset:30076
  s_waitcnt lgkmcnt(0)
  v_readfirstlane_b32 s78, v3
  s_nop 0
  s_cmp_ge_u32 s78, 4
  s_cbranch_scc1 SPE_27
  s_sub_u32 s79, s79, 1
  s_cbranch_scc0 SP_26
SPE_27:
OK_25:
  ds_read_b128 v[64:67], v38 offset:2048
  v_mfma_f32_32x32x16_bf16 v[96:111], v[164:167], v[76:79], v[96:111]
  ds_read_b128 v[68:71], v38 offset:3072
  v_mfma_f32_32x32x16_bf16 v[96:111], v[192:195], v[80:83], v[96:111]
  ds_read_b128 v[72:75], v38 offset:18432
  v_mfma_f32_32x32x16_bf16 v[96:111], v[196:199], v[84:87], v[96:111]
  ds_read_b128 v[76:79], v38 offset:19456
  s_waitcnt lgkmcnt(5)
  v_mfma_f32_32x32x16_bf16 v[96:111], v[224:227], v[88:91], v[96:111]
  ds_read_b128 v[80:83], v38 offset:34816
  s_waitcnt lgkmcnt(5)
  v_mfma_f32_32x32x16_bf16 v[96:111], v[228:231], v[92:95], v[96:111]
  s_waitcnt vmcnt(0)
  s_mov_b64 exec, 1
  ds_add_u32 v1, v2 offset:30084
  s_mov_b64 exec, -1
  ds_read_b128 v[84:87], v38 offset:35840
  s_waitcnt lgkmcnt(6)
  v_mfma_f32_32x32x16_bf16 v[96:111], v[136:139], v[64:67], v[96:111]
  ds_read_b32 v7, v1 offset:30084
  ds_read_b128 v[88:91], v38 offset:51200
  s_waitcnt lgkmcnt(7)
  v_mfma_f32_32x32x16_bf16 v[96:111], v[140:143], v[68:71], v[96:111]
  ds_read_b128 v[92:95], v38 offset:52224
  s_waitcnt lgkmcnt(7)
  v_mfma_f32_32x32x16_bf16 v[96:111], v[168:171], v[72:75], v[96:111]
  s_waitcnt lgkmcnt(2)
  v_readfirstlane_b32 s78, v7
  s_nop 0
  s_cmp_ge_u32 s78, 4
  s_cbranch_scc1 OK_28
  s_mov_b32 s79, 1000000
SP_29:
  ds_read_b32 v3, v1 offset:30084
  s_waitcnt lgkmcnt(0)
  v_readfirstlane_b32 s78, v3
  s_nop 0
  s_cmp_ge_u32 s78, 4
  s_cbranch_scc1 SPE_30
  s_sub_u32 s79, s79, 1
  s_cbranch_scc0 SP_29
SPE_30:
OK_28:
  ds_read_b128 v[64:67], v38 offset:8192
  v_mfma_f32_32x32x16_bf16 v[96:111], v[172:175], v[76:79], v[96:111]
  ds_read_b128 v[68:71], v38 offset:9216
  v_mfma_f32_32x32x16_bf16 v[96:111], v[200:203], v[80:83], v[96:111]
  ds_read_b128 v[72:75], v38 offset:24576
  v_mfma_f32_32x32x16_bf16 v[96:111], v[204:207], v[84:87], v[96:111]
  ds_read_b128 v[76:79], v38 offset:25600
  s_waitcnt lgkmcnt(5)
  v_mfma_f32_32x32x16_bf16 v[96:111], v[232:235], v[88:91], v[96:111]
  ds_read_b128 v[80:83], v38 offset:40960
  s_waitcnt lgkmcnt(5)
  v_mfma_f32_32x32x16_bf16 v[96:111], v[236:239], v[92:95], v[96:111]
  ds_read_b128 v[84:87], v38 offset:41984
  s_waitcnt lgkmcnt(5)
  v_mfma_f32_32x32x16_bf16 v[96:111], v[144:147], v[64:67], v[96:111]
  ds_read_b128 v[88:91], v38 offset:57344
  s_waitcnt lgkmcnt(5)
  v_mfma_f32_32x32x16_bf16 v[96:111], v[148:151], v[68:71], v[96:111]
  ds_read_b128 v[92:95], v38 offset:58368
  s_waitcnt lgkmcnt(5)
  v_mfma_f32_32x32x16_bf16 v[96:111], v[176:179], v[72:75], v[96:111]
  ds_read_b128 v[64:67], v38 offset:10240
  s_waitcnt lgkmcnt(5)
  v_mfma_f32_32x32x16_bf16 v[96:111], v[180:183], v[76:79], v[96:111]
  ds_read_b128 v[68:71], v38 offset:11264
  s_waitcnt lgkmcnt(5)
  v_mfma_f32_32x32x16_bf16 v[96:111], v[208:211], v[80:83], v[96:111]
  ds_read_b128 v[72:75], v38 offset:26624
  s_waitcnt lgkmcnt(5)
  v_mfma_f32_32x32x16_bf16 v[96:111], v[212:215], v[84:87], v[96:111]
  ds_read_b128 v[76:79], v38 offset:27648
  s_waitcnt lgkmcnt(5)
  v_mfma_f32_32x32x16_bf16 v[96:111], v[240:243], v[88:91], v[96:111]
  ds_read_b128 v[80:83], v38 offset:43008
  s_waitcnt lgkmcnt(5)
  v_mfma_f32_32x32x16_bf16 v[96:111], v[244:247], v[92:95], v[96:111]
  ds_read_b128 v[84:87], v38 offset:44032
  s_waitcnt lgkmcnt(5)
  v_mfma_f32_32x32x16_bf16 v[96:111], v[152:155], v[64:67], v[96:111]
  ds_read_b128 v[88:91], v38 offset:59392
  s_waitcnt lgkmcnt(5)
  v_mfma_f32_32x32x16_bf16 v[96:111], v[156:159], v[68:71], v[96:111]
  ds_read_b128 v[92:95], v38 offset:60416
  s_waitcnt lgkmcnt(5)
  v_mfma_f32_32x32x16_bf16 v[96:111], v[184:187], v[72:75], v[96:111]
  s_waitcnt lgkmcnt(4)
  v_mfma_f32_32x32x16_bf16 v[96:111], v[188:191], v[76:79], v[96:111]
  s_waitcnt lgkmcnt(3)
  v_mfma_f32_32x32x16_bf16 v[96:111], v[216:219], v[80:83], v[96:111]
  s_waitcnt lgkmcnt(2)
  v_mfma_f32_32x32x16_bf16 v[96:111], v[220:223], v[84:87], v[96:111]
  s_waitcnt lgkmcnt(1)
  v_mfma_f32_32x32x16_bf16 v[96:111], v[248:251], v[88:91], v[96:111]
  s_waitcnt lgkmcnt(0)
  v_mfma_f32_32x32x16_bf16 v[96:111], v[252:255], v[92:95], v[96:111]
  s_nop 11
  v_cvt_pk_bf16_f32 v56, v96, v97
  v_cvt_pk_bf16_f32 v57, v98, v99
  v_cvt_pk_bf16_f32 v58, v100, v101
  v_cvt_pk_bf16_f32 v59, v102, v103
  buffer_store_dwordx4 v[56:59], v4, s[28:31], s48 offen offset:0 sc1
  v_cvt_pk_bf16_f32 v60, v104, v105
  v_cvt_pk_bf16_f32 v61, v106, v107
  v_cvt_pk_bf16_f32 v62, v108, v109
  v_cvt_pk_bf16_f32 v63, v110, v111
  buffer_store_dwordx4 v[60:63], v4, s[28:31], s48 offen offset:1024 sc1
  v_add_f32 v8, v96, v97
  v_mul_f32 v9, v96, v96
  v_add_f32 v10, v104, v105
  v_mul_f32 v11, v104, v104
  v_fmac_f32 v9, v97, v97
  v_fmac_f32 v11, v105, v105
  v_add_f32 v8, v8, v98
  v_fmac_f32 v9, v98, v98
  v_add_f32 v10, v10, v106
  v_fmac_f32 v11, v106, v106
  v_add_f32 v8, v8, v99
  v_fmac_f32 v9, v99, v99
  v_add_f32 v10, v10, v107
  v_fmac_f32 v11, v107, v107
  v_add_f32 v8, v8, v100
  v_fmac_f32 v9, v100, v100
  v_add_f32 v10, v10, v108
  v_fmac_f32 v11, v108, v108
  v_add_f32 v8, v8, v101
  v_fmac_f32 v9, v101, v101
  v_add_f32 v10, v10, v109
  v_fmac_f32 v11, v109, v109
  v_add_f32 v8, v8, v102
  v_fmac_f32 v9, v102, v102
  v_add_f32 v10, v10, v110
  v_fmac_f32 v11, v110, v110
  v_add_f32 v8, v8, v103
  v_fmac_f32 v9, v103, v103
  v_add_f32 v10, v10, v111
  v_fmac_f32 v11, v111, v111
  v_add_f32 v8, v8, v10
  v_add_f32 v9, v9, v11
  s_nop 1
  v_permlane32_swap_b32 v8, v9
  v_add_f32 v8, v8, v9
  s_nop 1
  v_mov_b32_dpp v9, v8 quad_perm:[1,1,1,1] row_mask:0xf bank_mask:0xf
  v_mov_b32_dpp v10, v8 quad_perm:[2,2,2,2] row_mask:0xf bank_mask:0xf
  v_mov_b32_dpp v11, v8 quad_perm:[3,3,3,3] row_mask:0xf bank_mask:0xf
  s_mov_b32 exec_lo, 0x11111111
  s_mov_b32 exec_hi, 0x11111111
  buffer_store_dwordx4 v[8:11], v29, s[28:31], s49 offen sc1
  s_mov_b64 exec, -1
  v_mov_b32 v12, v41
  s_add_u32 s70, s75, 98304
  v_add_u32 v14, s70, v4
  s_waitcnt vmcnt(0)
  v_mov_b32 v3, s68
  s_mov_b64 exec, 1
  s_cmp_lg_u32 s24, 1
  s_cbranch_scc1 FS_31
  buffer_store_dword v3, off, s[28:31], s43 offset:128
  s_branch FE_32
FS_31:
  buffer_store_dword v3, off, s[28:31], s43 offset:128 sc1
FE_32:
  s_mov_b64 exec, -1
  s_mov_b32 s79, 200000
  s_mov_b32 exec_hi, 0
PL_33:
  buffer_load_dword v48, v29, s[28:31], s25 offen offset:128 sc1
  s_waitcnt vmcnt(0)
  v_cmp_ne_u32 vcc, s68, v48
  s_nop 4
  s_cbranch_vccz PLE_34
  s_sub_u32 s79, s79, 1
  s_cbranch_scc0 PL_33
PLE_34:
  s_mov_b64 exec, -1
  s_cmp_eq_u32 s24, 1
  s_cbranch_scc1 PLF_35
  buffer_inv sc1
  s_waitcnt vmcnt(0)
PLF_35:
  s_add_u32 s46, s53, 4096
  s_add_u32 m0, s75, 32768
  s_nop 0
  buffer_load_dwordx4 v4, s[28:31], s53 offen offset:0 sc1 lds
  buffer_load_dwordx4 v4, s[28:31], s53 offen offset:1024 sc1 lds
  s_add_u32 m0, s75, 36864
  s_nop 0
  buffer_load_dwordx4 v4, s[28:31], s46 offen offset:0 sc1 lds
  buffer_load_dwordx4 v4, s[28:31], s46 offen offset:1024 sc1 lds
  s_add_u32 m0, s75, 32768
  s_nop 0
  buffer_load_dwordx4 v4, s[28:31], s53 offen offset:2048 sc1 lds
  buffer_load_dwordx4 v4, s[28:31], s53 offen offset:3072 sc1 lds
  s_add_u32 m0, s75, 36864
  s_nop 0
  buffer_load_dwordx4 v4, s[28:31], s46 offen offset:2048 sc1 lds
  buffer_load_dwordx4 v4, s[28:31], s46 offen offset:3072 sc1 lds
  s_xor_b32 s53, s53, 8192
  s_add_u32 s46, s53, 4096
  s_add_u32 m0, s75, 40960
  s_nop 0
  buffer_load_dwordx4 v4, s[28:31], s53 offen offset:0 sc1 lds
  buffer_load_dwordx4 v4, s[28:31], s53 offen offset:1024 sc1 lds
  s_add_u32 m0, s75, 45056
  s_nop 0
  buffer_load_dwordx4 v4, s[28:31], s46 offen offset:0 sc1 lds
  buffer_load_dwordx4 v4, s[28:31], s46 offen offset:1024 sc1 lds
  ds_read_b32 v7, v1 offset:30136
  s_waitcnt vmcnt(8)
  s_mov_b64 exec, 1
  ds_add_u32 v1, v2 offset:30088
  s_mov_b64 exec, -1
  s_add_u32 m0, s75, 40960
  s_nop 0
  buffer_load_dwordx4 v4, s[28:31], s53 offen offset:2048 sc1 lds
  buffer_load_dwordx4 v4, s[28:31], s53 offen offset:3072 sc1 lds
  s_add_u32 m0, s75, 45056
  s_nop 0
  buffer_load_dwordx4 v4, s[28:31], s46 offen offset:2048 sc1 lds
  buffer_load_dwordx4 v4, s[28:31], s46 offen offset:3072 sc1 lds
  s_waitcnt vmcnt(8)
  s_mov_b64 exec, 1
  ds_add_u32 v1, v2 offset:30024
  s_mov_b64 exec, -1
  buffer_load_dword v48, v39, s[28:31], s50 offen offset:0 sc1
  buffer_load_dword v49, v39, s[28:31], s50 offen offset:1024 sc1
  buffer_load_dword v50, v39, s[28:31], s50 offen offset:2048 sc1
  buffer_load_dword v51, v39, s[28:31], s50 offen offset:3072 sc1
  s_addk_i32 s50, 4096
  buffer_load_dword v52, v39, s[28:31], s50 offen offset:0 sc1
  buffer_load_dword v53, v39, s[28:31], s50 offen offset:1024 sc1
  buffer_load_dword v54, v39, s[28:31], s50 offen offset:2048 sc1
  buffer_load_dword v55, v39, s[28:31], s50 offen offset:3072 sc1
  s_waitcnt lgkmcnt(2)
  v_readfirstlane_b32 s78, v7
  s_nop 0
  s_cmp_ge_u32 s78, 4
  s_cbranch_scc1 OK_36
  s_mov_b32 s79, 1000000
SP_37:
  ds_read_b32 v3, v1 offset:30136
  s_waitcnt lgkmcnt(0)
  v_readfirstlane_b32 s78, v3
  s_nop 0
  s_cmp_ge_u32 s78, 4
  s_cbranch_scc1 SPE_38
  s_sub_u32 s79, s79, 1
  s_cbranch_scc0 SP_37
SPE_38:
OK_36:
  s_waitcnt vmcnt(8)
  s_mov_b64 exec, 1
  ds_add_u32 v1, v2 offset:30092
  s_mov_b64 exec, -1
  buffer_load_dwordx4 v[80:83], v4, s[28:31], s51 offen offset:0 sc1
  buffer_load_dwordx4 v[84:87], v4, s[28:31], s51 offen offset:1024 sc1
  buffer_load_dwordx4 v[88:91], v4, s[28:31], s51 offen offset:2048 sc1
  buffer_load_dwordx4 v[92:95], v4, s[28:31], s51 offen offset:3072 sc1
  s_addk_i32 s51, 4096
  buffer_load_dwordx4 v[96:99], v4, s[28:31], s51 offen offset:0 sc1
  buffer_load_dwordx4 v[100:103], v4, s[28:31], s51 offen offset:1024 sc1
  buffer_load_dwordx4 v[104:107], v4, s[28:31], s51 offen offset:2048 sc1
  buffer_load_dwordx4 v[108:111], v4, s[28:31], s51 offen offset:3072 sc1
  s_addk_i32 s51, 4096
  s_setprio 1
  s_waitcnt vmcnt(8)
  v_add_f32 v48, v48, v52
  v_add_f32 v49, v49, v53
  v_add_f32 v50, v50, v54
  v_add_f32 v51, v51, v55
  v_add_f32 v48, v48, v50
  v_add_f32 v49, v49, v51
  v_add_f32 v48, v48, v49
  v_mov_b32 v49, v48
  s_nop 1
  v_permlane16_swap_b32 v48, v49
  v_add_f32 v48, v48, v49
  v_mov_b32 v49, v48
  s_nop 1
  v_permlane32_swap_b32 v48, v49
  v_mul_f32 v48, 0x3b000000, v48
  v_mul_f32 v49, 0x3b000000, v49
  v_fma_f32 v49, -v48, v48, v49
  v_max_f32 v49, 0, v49
  v_add_f32 v49, 0x3727c5ac, v49
  v_rsq_f32 v49, v49
  s_nop 0
  v_mul_f32 v49, s82, v49
  ds_write_b64 v40, v[48:49] offset:28480
  s_mov_b64 exec, 1
  ds_add_u32 v1, v2 offset:30160
  s_mov_b64 exec, -1
  v_xor_b32 v8, 0x2000, v43
  ds_read_b128 v[48:51], v43 offset:0
  ds_read_b128 v[64:67], v8 offset:0
  ds_read_b128 v[52:55], v43 offset:256
  ds_read_b128 v[68:71], v8 offset:256
  ds_read_b128 v[56:59], v43 offset:2048
  ds_read_b128 v[72:75], v8 offset:2048
  ds_read_b128 v[60:63], v43 offset:2304
  ds_read_b128 v[76:79], v8 offset:2304
  s_waitcnt lgkmcnt(4)
  v_add_f32 v48, v48, v64
  v_add_f32 v49, v49, v65
  v_add_f32 v50, v50, v66
  v_add_f32 v51, v51, v67
  v_add_f32 v52, v52, v68
  v_add_f32 v53, v53, v69
  v_add_f32 v54, v54, v70
  v_add_f32 v55, v55, v71
  v_cvt_pk_bf16_f32 v64, v48, v49
  v_cvt_pk_bf16_f32 v65, v50, v51
  v_cvt_pk_bf16_f32 v66, v52, v53
  v_cvt_pk_bf16_f32 v67, v54, v55
  buffer_store_dwordx4 v[64:67], v4, s[28:31], s39 offen offset:0 sc1
  s_waitcnt lgkmcnt(0)
  v_add_f32 v56, v56, v72
  v_add_f32 v57, v57, v73
  v_add_f32 v58, v58, v74
  v_add_f32 v59, v59, v75
  v_add_f32 v60, v60, v76
  v_add_f32 v61, v61, v77
  v_add_f32 v62, v62, v78
  v_add_f32 v63, v63, v79
  v_cvt_pk_bf16_f32 v72, v56, v57
  v_cvt_pk_bf16_f32 v73, v58, v59
  v_cvt_pk_bf16_f32 v74, v60, v61
  v_cvt_pk_bf16_f32 v75, v62, v63
  buffer_store_dwordx4 v[72:75], v4, s[28:31], s39 offen offset:1024 sc1
  v_mov_b32 v9, v44
  v_mov_b32 v10, v45
  s_lshl_b32 s70, s3, 13
  s_add_u32 s70, s70, 131072
  v_add_u32 v8, s70, v4
  v_xor_b32 v11, 0x3000, v8
  ds_read_b128 v[16:19], v9 offset:0
  ds_read_b128 v[32:35], v9 offset:256
  ds_read_b128 v[20:23], v9 offset:32
  ds_read_b128 v[36:39], v9 offset:288
  ds_read_b128 v[24:27], v9 offset:64
  ds_read_b128 v[40:43], v9 offset:320
  ds_read_b128 v[28:31], v9 offset:96
  ds_read_b128 v[44:47], v9 offset:352
  s_waitcnt vmcnt(8)
  buffer_load_dwordx4 v[112:115], v4, s[28:31], s51 offen offset:0 sc1
  buffer_load_dwordx4 v[116:119], v4, s[28:31], s51 offen offset:1024 sc1
  s_waitcnt vmcnt(8)
  buffer_load_dwordx4 v[120:123], v4, s[28:31], s51 offen offset:2048 sc1
  buffer_load_dwordx4 v[124:127], v4, s[28:31], s51 offen offset:3072 sc1
  s_addk_i32 s51, 4096
  s_waitcnt vmcnt(8)
  buffer_load_dwordx4 v[128:131], v4, s[28:31], s51 offen offset:0 sc1
  buffer_load_dwordx4 v[132:135], v4, s[28:31], s51 offen offset:1024 sc1
  s_mov_b32 s79, 1000000
SP_39:
  ds_read_b32 v3, v1 offset:30160
  s_waitcnt lgkmcnt(0)
  v_readfirstlane_b32 s78, v3
  s_nop 0
  s_cmp_ge_u32 s78, 4
  s_cbranch_scc1 SPE_40
  s_sub_u32 s79, s79, 1
  s_cbranch_scc0 SP_39
SPE_40:
  v_add_f32 v16, v16, v32
  v_add_f32 v17, v17, v33
  v_add_f32 v18, v18, v34
  v_add_f32 v19, v19, v35
  v_add_f32 v20, v20, v36
  v_add_f32 v21, v21, v37
  v_add_f32 v22, v22, v38
  v_add_f32 v23, v23, v39
  v_add_f32 v24, v24, v40
  v_add_f32 v25, v25, v41
  v_add_f32 v26, v26, v42
  v_add_f32 v27, v27, v43
  v_add_f32 v28, v28, v44
  v_add_f32 v29, v29, v45
  v_add_f32 v30, v30, v46
  v_add_f32 v31, v31, v47
  ds_read_b64 v[38:39], v10 offset:28480
  s_mov_b32 s79, 1000000
SP_41:
  ds_read_b32 v3, v1 offset:30140
  s_waitcnt lgkmcnt(0)
  v_readfirstlane_b32 s78, v3
  s_nop 0
  s_cmp_ge_u32 s78, 4
  s_cbranch_scc1 SPE_42
  s_sub_u32 s79, s79, 1
  s_cbranch_scc0 SP_41
SPE_42:
  ds_read_b128 v[48:51], v8 offset:0
  ds_read_b128 v[240:243], v11 offset:0
  ds_read_b128 v[52:55], v8 offset:1024
  ds_read_b128 v[244:247], v11 offset:1024
  ds_read_b128 v[56:59], v8 offset:2048
  ds_read_b128 v[248:251], v11 offset:2048
  ds_read_b128 v[60:63], v8 offset:3072
  ds_read_b128 v[252:255], v11 offset:3072
  s_mov_b64 exec, 1
  ds_add_u32 v1, v2 offset:30140
  s_mov_b64 exec, -1
  s_waitcnt lgkmcnt(7)
  v_add_f32 v48, v48, v240
  v_add_f32 v49, v49, v241
  v_add_f32 v50, v50, v242
  v_add_f32 v51, v51, v243
  s_waitcnt lgkmcnt(5)
  v_add_f32 v52, v52, v244
  v_add_f32 v53, v53, v245
  v_add_f32 v54, v54, v246
  v_add_f32 v55, v55, v247
  s_waitcnt lgkmcnt(3)
  v_add_f32 v56, v56, v248
  v_add_f32 v57, v57, v249
  v_add_f32 v58, v58, v250
  v_add_f32 v59, v59, v251
  s_waitcnt lgkmcnt(1)
  v_add_f32 v60, v60, v252
  v_add_f32 v61, v61, v253
  v_add_f32 v62, v62, v254
  v_add_f32 v63, v63, v255
  v_fma_f32 v48, -v16, v38, v48
  v_fma_f32 v50, -v18, v38, v50
  v_fma_f32 v49, -v17, v38, v49
  v_fma_f32 v51, -v19, v38, v51
  v_mul_f32 v48, v48, v39
  v_mul_f32 v50, v50, v39
  v_mul_f32 v49, v49, v39
  v_mul_f32 v51, v51, v39
  v_fma_f32 v32, -v48, v48, -s80
  v_fma_f32 v34, -v50, v50, -s80
  v_fma_f32 v33, -v49, v49, -s80
  v_fma_f32 v35, -v51, v51, -s80
  v_mul_f32 v32, v32, v48
  v_mul_f32 v34, v34, v50
  v_mul_f32 v33, v33, v49
  v_mul_f32 v35, v35, v51
  v_exp_f32 v32, v32
  v_exp_f32 v34, v34
  v_exp_f32 v33, v33
  v_exp_f32 v35, v35
  s_waitcnt vmcnt(8)
  buffer_load_dwordx4 v[136:139], v4, s[28:31], s51 offen offset:2048 sc1
  buffer_load_dwordx4 v[140:143], v4, s[28:31], s51 offen offset:3072 sc1
  s_addk_i32 s51, 4096
  v_fma_f32 v32, v32, s82, s82
  v_fma_f32 v34, v34, s82, s82
  v_fma_f32 v33, v33, s82, s82
  v_fma_f32 v35, v35, s82, s82
  v_rcp_f32 v32, v32
  v_rcp_f32 v34, v34
  v_rcp_f32 v33, v33
  v_rcp_f32 v35, v35
  v_mul_f32 v32, v32, v48
  v_mul_f32 v34, v34, v50
  v_mul_f32 v33, v33, v49
  v_mul_f32 v35, v35, v51
  v_cvt_pk_bf16_f32 v48, v32, v33
  v_cvt_pk_bf16_f32 v49, v34, v35
  v_fma_f32 v52, -v20, v38, v52
  v_fma_f32 v54, -v22, v38, v54
  v_fma_f32 v53, -v21, v38, v53
  v_fma_f32 v55, -v23, v38, v55
  v_mul_f32 v52, v52, v39
  v_mul_f32 v54, v54, v39
  s_waitcnt vmcnt(6)
  buffer_load_dwordx4 v[144:147], v4, s[28:31], s51 offen offset:0 sc1
  buffer_load_dwordx4 v[148:151], v4, s[28:31], s51 offen offset:1024 sc1
  v_mul_f32 v53, v53, v39
  v_mul_f32 v55, v55, v39
  v_fma_f32 v32, -v52, v52, -s80
  v_fma_f32 v34, -v54, v54, -s80
  v_fma_f32 v33, -v53, v53, -s80
  v_fma_f32 v35, -v55, v55, -s80
  v_mul_f32 v32, v32, v52
  v_mul_f32 v34, v34, v54
  v_mul_f32 v33, v33, v53
  v_mul_f32 v35, v35, v55
  v_exp_f32 v32, v32
  v_exp_f32 v34, v34
  v_exp_f32 v33, v33
  v_exp_f32 v35, v35
  v_fma_f32 v32, v32, s82, s82
  v_fma_f32 v34, v34, s82, s82
  v_fma_f32 v33, v33, s82, s82
  v_fma_f32 v35, v35, s82, s82
  v_rcp_f32 v32, v32
  v_rcp_f32 v34, v34
  s_waitcnt vmcnt(6)
  buffer_load_dwordx4 v[152:155], v4, s[28:31], s51 offen offset:2048 sc1
  buffer_load_dwordx4 v[156:159], v4, s[28:31], s51 offen offset:3072 sc1
  s_addk_i32 s51, 4096
  v_rcp_f32 v33, v33
  v_rcp_f32 v35, v35
  v_mul_f32 v32, v32, v52
  v_mul_f32 v34, v34, v54
  v_mul_f32 v33, v33, v53
  v_mul_f32 v35, v35, v55
  v_cvt_pk_bf16_f32 v50, v32, v33
  v_cvt_pk_bf16_f32 v51, v34, v35
  v_and_b32 v48, s60, v48
  v_and_b32 v49, s60, v49
  v_and_b32 v50, s60, v50
  v_and_b32 v51, s60, v51
  buffer_store_dwordx4 v[48:51], v4, s[28:31], s58 offen offset:0 sc1
  v_fma_f32 v56, -v24, v38, v56
  v_fma_f32 v58, -v26, v38, v58
  v_fma_f32 v57, -v25, v38, v57
  v_fma_f32 v59, -v27, v38, v59
  v_mul_f32 v56, v56, v39
  v_mul_f32 v58, v58, v39
  v_mul_f32 v57, v57, v39
  s_waitcnt vmcnt(7)
  buffer_load_dwordx4 v[160:163], v4, s[28:31], s51 offen offset:0 sc1
  buffer_load_dwordx4 v[164:167], v4, s[28:31], s51 offen offset:1024 sc1
  v_mul_f32 v59, v59, v39
  v_fma_f32 v32, -v56, v56, -s80
  v_fma_f32 v34, -v58, v58, -s80
  v_fma_f32 v33, -v57, v57, -s80
  v_fma_f32 v35, -v59, v59, -s80
  v_mul_f32 v32, v32, v56
  v_mul_f32 v34, v34, v58
  v_mul_f32 v33, v33, v57
  v_mul_f32 v35, v35, v59
  v_exp_f32 v32, v32
  v_exp_f32 v34, v34
  v_exp_f32 v33, v33
  v_exp_f32 v35, v35
  v_fma_f32 v32, v32, s82, s82
  v_fma_f32 v34, v34, s82, s82
  v_fma_f32 v33, v33, s82, s82
  v_fma_f32 v35, v35, s82, s82
  v_rcp_f32 v32, v32
  v_rcp_f32 v34, v34
  v_rcp_f32 v33, v33
  s_waitcnt vmcnt(7)
  buffer_load_dwordx4 v[168:171], v4, s[28:31], s51 offen offset:2048 sc1
  buffer_load_dwordx4 v[172:175], v4, s[28:31], s51 offen offset:3072 sc1
  s_addk_i32 s51, 4096
  v_rcp_f32 v35, v35
  v_mul_f32 v32, v32, v56
  v_mul_f32 v34, v34, v58
  v_mul_f32 v33, v33, v57
  v_mul_f32 v35, v35, v59
  v_cvt_pk_bf16_f32 v56, v32, v33
  v_cvt_pk_bf16_f32 v57, v34, v35
  v_fma_f32 v60, -v28, v38, v60
  v_fma_f32 v62, -v30, v38, v62
  v_fma_f32 v61, -v29, v38, v61
  v_fma_f32 v63, -v31, v38, v63
  v_mul_f32 v60, v60, v39
  v_mul_f32 v62, v62, v39
  v_mul_f32 v61, v61, v39
  v_mul_f32 v63, v63, v39
  v_fma_f32 v32, -v60, v60, -s80
  v_fma_f32 v34, -v62, v62, -s80
  v_fma_f32 v33, -v61, v61, -s80
  v_fma_f32 v35, -v63, v63, -s80
  v_mul_f32 v32, v32, v60
  s_waitcnt vmcnt(7)
  buffer_load_dwordx4 v[176:179], v4, s[28:31], s51 offen offset:0 sc1
  buffer_load_dwordx4 v[180:183], v4, s[28:31], s51 offen offset:1024 sc1
  v_mul_f32 v34, v34, v62
  v_mul_f32 v33, v33, v61
  v_mul_f32 v35, v35, v63
  v_exp_f32 v32, v32
  v_exp_f32 v34, v34
  v_exp_f32 v33, v33
  v_exp_f32 v35, v35
  v_fma_f32 v32, v32, s82, s82
  v_fma_f32 v34, v34, s82, s82
  v_fma_f32 v33, v33, s82, s82
  v_fma_f32 v35, v35, s82, s82
  v_rcp_f32 v32, v32
  v_rcp_f32 v34, v34
  v_rcp_f32 v33, v33
  v_rcp_f32 v35, v35
  v_mul_f32 v32, v32, v60
  v_mul_f32 v34, v34, v62
  v_mul_f32 v33, v33, v61
  v_mul_f32 v35, v35, v63
  v_cvt_pk_bf16_f32 v58, v32, v33
  s_waitcnt vmcnt(7)
  buffer_load_dwordx4 v[184:187], v4, s[28:31], s51 offen offset:2048 sc1
  buffer_load_dwordx4 v[188:191], v4, s[28:31], s51 offen offset:3072 sc1
  s_addk_i32 s51, 4096
  v_cvt_pk_bf16_f32 v59, v34, v35
  buffer_store_dwordx4 v[56:59], v4, s[28:31], s59 offen offset:1024 sc1
  s_setprio 0
  s_mov_b64 exec, 1
  ds_add_rtn_u32 v3, v1, v2 offset:30116
  s_waitcnt lgkmcnt(0)
  v_readfirstlane_b32 s78, v3
  s_nop 0
  s_cmp_eq_u32 s78, 3
  s_cbranch_scc0 PB_43
  v_mov_b32 v3, s68
  buffer_store_dword v3, off, s[28:31], s26 offset:1024 sc1
PB_43:
  s_mov_b64 exec, -1
  s_waitcnt vmcnt(7)
  buffer_load_dwordx4 v[192:195], v4, s[28:31], s51 offen offset:0 sc1
  buffer_load_dwordx4 v[196:199], v4, s[28:31], s51 offen offset:1024 sc1
  s_waitcnt vmcnt(7)
  buffer_load_dwordx4 v[200:203], v4, s[28:31], s51 offen offset:2048 sc1
  buffer_load_dwordx4 v[204:207], v4, s[28:31], s51 offen offset:3072 sc1
  s_addk_i32 s51, 4096
  s_waitcnt vmcnt(7)
  buffer_load_dwordx4 v[208:211], v4, s[28:31], s51 offen offset:0 sc1
  buffer_load_dwordx4 v[212:215], v4, s[28:31], s51 offen offset:1024 sc1
  s_waitcnt vmcnt(7)
  buffer_load_dwordx4 v[216:219], v4, s[28:31], s51 offen offset:2048 sc1
  buffer_load_dwordx4 v[220:223], v4, s[28:31], s51 offen offset:3072 sc1
  s_addk_i32 s51, 4096
  v_lshlrev_b32 v9, 7, v0
  s_waitcnt vmcnt(8)
  v_mov_b32 v3, s68
  s_mov_b64 exec, 1
  s_cmp_lg_u32 s24, 1
  s_cbranch_scc1 FS_44
  buffer_store_dword v3, off, s[28:31], s43 offset:256
  s_branch FE_45
FS_44:
  buffer_store_dword v3, off, s[28:31], s43 offset:256 sc1
FE_45:
  s_mov_b64 exec, -1
  s_waitcnt vmcnt(7)
  buffer_load_dwordx4 v[224:227], v4, s[28:31], s51 offen offset:0 sc1
  buffer_load_dwordx4 v[228:231], v4, s[28:31], s51 offen offset:1024 sc1
  s_waitcnt vmcnt(7)
  buffer_load_dwordx4 v[232:235], v4, s[28:31], s51 offen offset:2048 sc1
  buffer_load_dwordx4 v[236:239], v4, s[28:31], s51 offen offset:3072 sc1
  s_addk_i32 s51, 4096
  s_waitcnt vmcnt(7)
  buffer_load_dwordx4 v[240:243], v4, s[28:31], s51 offen offset:0 sc1
  buffer_load_dwordx4 v[244:247], v4, s[28:31], s51 offen offset:1024 sc1
  s_waitcnt vmcnt(7)
  buffer_load_dwordx4 v[248:251], v4, s[28:31], s51 offen offset:2048 sc1
  buffer_load_dwordx4 v[252:255], v4, s[28:31], s51 offen offset:3072 sc1
  s_addk_i32 s51, 4096
  s_mov_b32 s79, 1000000
SP_46:
  ds_read_b32 v3, v1 offset:30140
  s_waitcnt lgkmcnt(0)
  v_readfirstlane_b32 s78, v3
  s_nop 0
  s_cmp_ge_u32 s78, 8
  s_cbranch_scc1 SPE_47
  s_sub_u32 s79, s79, 1
  s_cbranch_scc0 SP_46
SPE_47:
  s_mov_b32 s79, 200000
  s_mov_b64 exec, 0xffff
PL_48:
  buffer_load_dword v6, v12, s[28:31], s44 offen offset:256 sc1
  s_waitcnt vmcnt(0)
  v_cmp_ne_u32 vcc, s68, v6
  s_nop 4
  s_cbranch_vccz PLE_49
  s_sub_u32 s79, s79, 1
  s_cbranch_scc0 PL_48
PLE_49:
  s_mov_b64 exec, -1
  s_cmp_eq_u32 s24, 1
  s_cbranch_scc1 PLF_50
  buffer_inv sc1
  s_waitcnt vmcnt(0)
PLF_50:
  s_setprio 1
  s_add_u32 s71, s55, 0
  buffer_load_dwordx4 v[16:19], v4, s[28:31], s71 offen offset:0 sc1
  buffer_load_dwordx4 v[20:23], v4, s[28:31], s71 offen offset:1024 sc1
  buffer_load_dwordx4 v[24:27], v4, s[28:31], s71 offen offset:2048 sc1
  buffer_load_dwordx4 v[28:31], v4, s[28:31], s71 offen offset:3072 sc1
  s_add_u32 s71, s55, 4096
  buffer_load_dwordx4 v[32:35], v4, s[28:31], s71 offen offset:0 sc1
  buffer_load_dwordx4 v[36:39], v4, s[28:31], s71 offen offset:1024 sc1
  buffer_load_dwordx4 v[40:43], v4, s[28:31], s71 offen offset:2048 sc1
  buffer_load_dwordx4 v[44:47], v4, s[28:31], s71 offen offset:3072 sc1
  s_waitcnt vmcnt(7)
  v_mfma_f32_32x32x16_bf16 v[48:63], v[80:83], v[16:19], 0
  v_mfma_f32_32x32x16_bf16 v[64:79], v[84:87], v[16:19], 0
  s_add_u32 s71, s55, 8192
  buffer_load_dwordx4 v[16:19], v4, s[28:31], s71 offen offset:0 sc1
  s_waitcnt vmcnt(7)
  v_mfma_f32_32x32x16_bf16 v[48:63], v[88:91], v[20:23], v[48:63]
  v_mfma_f32_32x32x16_bf16 v[64:79], v[92:95], v[20:23], v[64:79]
  buffer_load_dwordx4 v[20:23], v4, s[28:31], s71 offen offset:1024 sc1
  s_waitcnt vmcnt(7)
  v_mfma_f32_32x32x16_bf16 v[48:63], v[96:99], v[24:27], v[48:63]
  v_mfma_f32_32x32x16_bf16 v[64:79], v[100:103], v[24:27], v[64:79]
  buffer_load_dwordx4 v[24:27], v4, s[28:31], s71 offen offset:2048 sc1
  s_waitcnt vmcnt(7)
  v_mfma_f32_32x32x16_bf16 v[48:63], v[104:107], v[28:31], v[48:63]
  v_mfma_f32_32x32x16_bf16 v[64:79], v[108:111], v[28:31], v[64:79]
  buffer_load_dwordx4 v[28:31], v4, s[28:31], s71 offen offset:3072 sc1
  s_waitcnt vmcnt(7)
  v_mfma_f32_32x32x16_bf16 v[48:63], v[112:115], v[32:35], v[48:63]
  v_mfma_f32_32x32x16_bf16 v[64:79], v[116:119], v[32:35], v[64:79]
  s_add_u32 s71, s55, 12288
  buffer_load_dwordx4 v[32:35], v4, s[28:31], s71 offen offset:0 sc1
  s_waitcnt vmcnt(7)
  v_mfma_f32_32x32x16_bf16 v[48:63], v[120:123], v[36:39], v[48:63]
  v_mfma_f32_32x32x16_bf16 v[64:79], v[124:127], v[36:39], v[64:79]
  buffer_load_dwordx4 v[36:39], v4, s[28:31], s71 offen offset:1024 sc1
  s_mov_b64 exec, 0xff
  buffer_load_dword v6, v12, s[28:31], s44 offen offset:512 sc1
  s_mov_b64 exec, -1
  s_waitcnt vmcnt(8)
  v_mfma_f32_32x32x16_bf16 v[48:63], v[128:131], v[40:43], v[48:63]
  v_mfma_f32_32x32x16_bf16 v[64:79], v[132:135], v[40:43], v[64:79]
  buffer_load_dwordx4 v[40:43], v4, s[28:31], s71 offen offset:2048 sc1
  s_waitcnt vmcnt(8)
  v_mfma_f32_32x32x16_bf16 v[48:63], v[136:139], v[44:47], v[48:63]
  v_mfma_f32_32x32x16_bf16 v[64:79], v[140:143], v[44:47], v[64:79]
  buffer_load_dwordx4 v[44:47], v4, s[28:31], s71 offen offset:3072 sc1
  s_waitcnt vmcnt(8)
  v_mfma_f32_32x32x16_bf16 v[48:63], v[144:147], v[16:19], v[48:63]
  v_mfma_f32_32x32x16_bf16 v[64:79], v[148:151], v[16:19], v[64:79]
  s_add_u32 s71, s55, 16384
  buffer_load_dwordx4 v[16:19], v4, s[28:31], s71 offen offset:0 sc1
  s_waitcnt vmcnt(8)
  v_mfma_f32_32x32x16_bf16 v[48:63], v[152:155], v[20:23], v[48:63]
  v_mfma_f32_32x32x16_bf16 v[64:79], v[156:159], v[20:23], v[64:79]
  buffer_load_dwordx4 v[20:23], v4, s[28:31], s71 offen offset:1024 sc1
  s_waitcnt vmcnt(8)
  v_mfma_f32_32x32x16_bf16 v[48:63], v[160:163], v[24:27], v[48:63]
  v_mfma_f32_32x32x16_bf16 v[64:79], v[164:167], v[24:27], v[64:79]
  buffer_load_dwordx4 v[24:27], v4, s[28:31], s71 offen offset:2048 sc1
  s_waitcnt vmcnt(8)
  v_mfma_f32_32x32x16_bf16 v[48:63], v[168:171], v[28:31], v[48:63]
  v_mfma_f32_32x32x16_bf16 v[64:79], v[172:175], v[28:31], v[64:79]
  buffer_load_dwordx4 v[28:31], v4, s[28:31], s71 offen offset:3072 sc1
  s_waitcnt vmcnt(8)
  v_mfma_f32_32x32x16_bf16 v[48:63], v[176:179], v[32:35], v[48:63]
  v_mfma_f32_32x32x16_bf16 v[64:79], v[180:183], v[32:35], v[64:79]
  s_add_u32 s71, s55, 20480
  buffer_load_dwordx4 v[32:35], v4, s[28:31], s71 offen offset:0 sc1
  s_waitcnt vmcnt(8)
  v_mfma_f32_32x32x16_bf16 v[48:63], v[184:187], v[36:39], v[48:63]
  v_mfma_f32_32x32x16_bf16 v[64:79], v[188:191], v[36:39], v[64:79]
  buffer_load_dwordx4 v[36:39], v4, s[28:31], s71 offen offset:1024 sc1
  s_waitcnt vmcnt(8)
  s_mov_b64 exec, 0xff
  v_cmp_ne_u32 vcc, s68, v6
  s_mov_b64 exec, -1
  s_cmp_eq_u32 s24, 1
  s_cselect_b64 vcc, vcc, -1
  s_nop 1
  s_cbranch_vccz HB_51
  s_mov_b32 s79, 200000
  s_mov_b64 exec, 0xff
PL_52:
  buffer_load_dword v6, v12, s[28:31], s44 offen offset:512 sc1
  s_waitcnt vmcnt(0)
  v_cmp_ne_u32 vcc, s68, v6
  s_nop 4
  s_cbranch_vccz PLE_53
  s_sub_u32 s79, s79, 1
  s_cbranch_scc0 PL_52
PLE_53:
  s_mov_b64 exec, -1
  s_cmp_eq_u32 s24, 1
  s_cbranch_scc1 PLF_54
  buffer_inv sc1
  s_waitcnt vmcnt(0)
PLF_54:
HB_51:
  s_waitcnt vmcnt(7)
  v_mfma_f32_32x32x16_bf16 v[48:63], v[192:195], v[40:43], v[48:63]
  v_mfma_f32_32x32x16_bf16 v[64:79], v[196:199], v[40:43], v[64:79]
  s_add_u32 s71, s55, 90112
  buffer_load_dwordx4 v[40:43], v4, s[28:31], s71 offen offset:0 sc1
  s_waitcnt vmcnt(7)
  v_mfma_f32_32x32x16_bf16 v[48:63], v[200:203], v[44:47], v[48:63]
  v_mfma_f32_32x32x16_bf16 v[64:79], v[204:207], v[44:47], v[64:79]
  buffer_load_dwordx4 v[44:47], v4, s[28:31], s71 offen offset:1024 sc1
  s_waitcnt vmcnt(7)
  v_mfma_f32_32x32x16_bf16 v[48:63], v[208:211], v[16:19], v[48:63]
  v_mfma_f32_32x32x16_bf16 v[64:79], v[212:215], v[16:19], v[64:79]
  buffer_load_dwordx4 v[16:19], v4, s[28:31], s71 offen offset:2048 sc1
  s_waitcnt vmcnt(7)
  v_mfma_f32_32x32x16_bf16 v[48:63], v[216:219], v[20:23], v[48:63]
  v_mfma_f32_32x32x16_bf16 v[64:79], v[220:223], v[20:23], v[64:79]
  buffer_load_dwordx4 v[20:23], v4, s[28:31], s71 offen offset:3072 sc1
  s_waitcnt vmcnt(7)
  v_mfma_f32_32x32x16_bf16 v[48:63], v[224:227], v[24:27], v[48:63]
  v_mfma_f32_32x32x16_bf16 v[64:79], v[228:231], v[24:27], v[64:79]
  s_add_u32 s71, s55, 94208
  buffer_load_dwordx4 v[24:27], v4, s[28:31], s71 offen offset:0 sc1
  s_waitcnt vmcnt(7)
  v_mfma_f32_32x32x16_bf16 v[48:63], v[232:235], v[28:31], v[48:63]
  v_mfma_f32_32x32x16_bf16 v[64:79], v[236:239], v[28:31], v[64:79]
  buffer_load_dwordx4 v[28:31], v4, s[28:31], s71 offen offset:1024 sc1
  s_waitcnt vmcnt(7)
  v_mfma_f32_32x32x16_bf16 v[48:63], v[240:243], v[32:35], v[48:63]
  v_mfma_f32_32x32x16_bf16 v[64:79], v[244:247], v[32:35], v[64:79]
  buffer_load_dwordx4 v[32:35], v4, s[28:31], s71 offen offset:2048 sc1
  s_waitcnt vmcnt(7)
  v_mfma_f32_32x32x16_bf16 v[48:63], v[248:251], v[36:39], v[48:63]
  v_mfma_f32_32x32x16_bf16 v[64:79], v[252:255], v[36:39], v[64:79]
  buffer_load_dwordx4 v[36:39], v4, s[28:31], s71 offen offset:3072 sc1
  s_nop 9
  ds_write_b128 v14, v[48:51] offset:0
  ds_write_b128 v14, v[52:55] offset:1024
  ds_write_b128 v14, v[56:59] offset:2048
  ds_write_b128 v14, v[60:63] offset:3072
  ds_write_b128 v14, v[64:67] offset:4096
  ds_write_b128 v14, v[68:71] offset:5120
  ds_write_b128 v14, v[72:75] offset:6144
  ds_write_b128 v14, v[76:79] offset:7168
  s_mov_b64 exec, 1
  ds_add_u32 v1, v2 offset:30120
  s_mov_b64 exec, -1
  s_waitcnt vmcnt(7)
  s_waitcnt lgkmcnt(5)
  v_mfma_f32_32x32x16_bf16 v[48:63], v[80:83], v[40:43], 0
  s_waitcnt lgkmcnt(1)
  v_mfma_f32_32x32x16_bf16 v[64:79], v[84:87], v[40:43], 0
  s_add_u32 s71, s55, 98304
  buffer_load_dwordx4 v[40:43], v4, s[28:31], s71 offen offset:0 sc1
  s_waitcnt vmcnt(7)
  v_mfma_f32_32x32x16_bf16 v[48:63], v[88:91], v[44:47], v[48:63]
  v_mfma_f32_32x32x16_bf16 v[64:79], v[92:95], v[44:47], v[64:79]
  buffer_load_dwordx4 v[44:47], v4, s[28:31], s71 offen offset:1024 sc1
  s_waitcnt vmcnt(7)
  v_mfma_f32_32x32x16_bf16 v[48:63], v[96:99], v[16:19], v[48:63]
  v_mfma_f32_32x32x16_bf16 v[64:79], v[100:103], v[16:19], v[64:79]
  buffer_load_dwordx4 v[16:19], v4, s[28:31], s71 offen offset:2048 sc1
  s_waitcnt vmcnt(7)
  v_mfma_f32_32x32x16_bf16 v[48:63], v[104:107], v[20:23], v[48:63]
  v_mfma_f32_32x32x16_bf16 v[64:79], v[108:111], v[20:23], v[64:79]
  buffer_load_dwordx4 v[20:23], v4, s[28:31], s71 offen offset:3072 sc1
  s_waitcnt vmcnt(7)
  v_mfma_f32_32x32x16_bf16 v[48:63], v[112:115], v[24:27], v[48:63]
  v_mfma_f32_32x32x16_bf16 v[64:79], v[116:119], v[24:27], v[64:79]
  s_add_u32 s71, s55, 102400
  buffer_load_dwordx4 v[24:27], v4, s[28:31], s71 offen offset:0 sc1
  s_waitcnt vmcnt(7)
  v_mfma_f32_32x32x16_bf16 v[48:63], v[120:123], v[28:31], v[48:63]
  v_mfma_f32_32x32x16_bf16 v[64:79], v[124:127], v[28:31], v[64:79]
  buffer_load_dwordx4 v[28:31], v4, s[28:31], s71 offen offset:1024 sc1
  s_waitcnt vmcnt(7)
  v_mfma_f32_32x32x16_bf16 v[48:63], v[128:131], v[32:35], v[48:63]
  v_mfma_f32_32x32x16_bf16 v[64:79], v[132:135], v[32:35], v[64:79]
  buffer_load_dwordx4 v[32:35], v4, s[28:31], s71 offen offset:2048 sc1
  s_waitcnt vmcnt(7)
  v_mfma_f32_32x32x16_bf16 v[48:63], v[136:139], v[36:39], v[48:63]
  v_mfma_f32_32x32x16_bf16 v[64:79], v[140:143], v[36:39], v[64:79]
  buffer_load_dwordx4 v[36:39], v4, s[28:31], s71 offen offset:3072 sc1
  s_waitcnt vmcnt(7)
  v_mfma_f32_32x32x16_bf16 v[48:63], v[144:147], v[40:43], v[48:63]
  v_mfma_f32_32x32x16_bf16 v[64:79], v[148:151], v[40:43], v[64:79]
  s_add_u32 s71, s55, 106496
  buffer_load_dwordx4 v[40:43], v4, s[28:31], s71 offen offset:0 sc1
  s_waitcnt vmcnt(7)
  v_mfma_f32_32x32x16_bf16 v[48:63], v[152:155], v[44:47], v[48:63]
  v_mfma_f32_32x32x16_bf16 v[64:79], v[156:159], v[44:47], v[64:79]
  buffer_load_dwordx4 v[44:47], v4, s[28:31], s71 offen offset:1024 sc1
  s_waitcnt vmcnt(7)
  v_mfma_f32_32x32x16_bf16 v[48:63], v[160:163], v[16:19], v[48:63]
  v_mfma_f32_32x32x16_bf16 v[64:79], v[164:167], v[16:19], v[64:79]
  buffer_load_dwordx4 v[16:19], v4, s[28:31], s71 offen offset:2048 sc1
  s_waitcnt vmcnt(7)
  v_mfma_f32_32x32x16_bf16 v[48:63], v[168:171], v[20:23], v[48:63]
  v_mfma_f32_32x32x16_bf16 v[64:79], v[172:175], v[20:23], v[64:79]
  buffer_load_dwordx4 v[20:23], v4, s[28:31], s71 offen offset:3072 sc1
  s_waitcnt vmcnt(7)
  v_mfma_f32_32x32x16_bf16 v[48:63], v[176:179], v[24:27], v[48:63]
  v_mfma_f32_32x32x16_bf16 v[64:79], v[180:183], v[24:27], v[64:79]
  s_add_u32 s71, s55, 110592
  buffer_load_dwordx4 v[24:27], v4, s[28:31], s71 offen offset:0 sc1
  s_waitcnt vmcnt(7)
  v_mfma_f32_32x32x16_bf16 v[48:63], v[184:187], v[28:31], v[48:63]
  v_mfma_f32_32x32x16_bf16 v[64:79], v[188:191], v[28:31], v[64:79]
  buffer_load_dwordx4 v[28:31], v4, s[28:31], s71 offen offset:1024 sc1
  s_waitcnt vmcnt(7)
  v_mfma_f32_32x32x16_bf16 v[48:63], v[192:195], v[32:35], v[48:63]
  v_mfma_f32_32x32x16_bf16 v[64:79], v[196:199], v[32:35], v[64:79]
  s_waitcnt vmcnt(6)
  v_mfma_f32_32x32x16_bf16 v[48:63], v[200:203], v[36:39], v[48:63]
  v_mfma_f32_32x32x16_bf16 v[64:79], v[204:207], v[36:39], v[64:79]
  s_waitcnt vmcnt(5)
  v_mfma_f32_32x32x16_bf16 v[48:63], v[208:211], v[40:43], v[48:63]
  v_mfma_f32_32x32x16_bf16 v[64:79], v[212:215], v[40:43], v[64:79]
  s_waitcnt vmcnt(4)
  v_mfma_f32_32x32x16_bf16 v[48:63], v[216:219], v[44:47], v[48:63]
  v_mfma_f32_32x32x16_bf16 v[64:79], v[220:223], v[44:47], v[64:79]
  s_waitcnt vmcnt(3)
  v_mfma_f32_32x32x16_bf16 v[48:63], v[224:227], v[16:19], v[48:63]
  v_mfma_f32_32x32x16_bf16 v[64:79], v[228:231], v[16:19], v[64:79]
  s_waitcnt vmcnt(2)
  v_mfma_f32_32x32x16_bf16 v[48:63], v[232:235], v[20:23], v[48:63]
  v_mfma_f32_32x32x16_bf16 v[64:79], v[236:239], v[20:23], v[64:79]
  s_waitcnt vmcnt(1)
  v_mfma_f32_32x32x16_bf16 v[48:63], v[240:243], v[24:27], v[48:63]
  v_mfma_f32_32x32x16_bf16 v[64:79], v[244:247], v[24:27], v[64:79]
  s_waitcnt vmcnt(0)
  v_mfma_f32_32x32x16_bf16 v[48:63], v[248:251], v[28:31], v[48:63]
  v_mfma_f32_32x32x16_bf16 v[64:79], v[252:255], v[28:31], v[64:79]
  s_nop 10
  ds_write_b128 v14, v[48:51] offset:8192
  ds_write_b128 v14, v[52:55] offset:9216
  ds_write_b128 v14, v[56:59] offset:10240
  ds_write_b128 v14, v[60:63] offset:11264
  ds_write_b128 v14, v[64:67] offset:12288
  ds_write_b128 v14, v[68:71] offset:13312
  ds_write_b128 v14, v[72:75] offset:14336
  ds_write_b128 v14, v[76:79] offset:15360
  s_mov_b64 exec, 1
  ds_add_u32 v1, v2 offset:30124
  s_mov_b64 exec, -1
  s_endpgm
L_B:
  s_lshr_b32 s75, s3, 1
  s_and_b32 s76, s3, 1
  v_and_b32 v8, 1, v0
  v_lshlrev_b32 v8, 4, v8
  v_mov_b32 v9, 0x3f80
  v_lshlrev_b32 v8, v8, v9
  s_mov_b32 vcc_lo, 0x3
  s_mov_b32 vcc_hi, 0x300
  v_cndmask_b32 v224, 0, v8, vcc
  s_mov_b32 vcc_lo, 0xc
  s_mov_b32 vcc_hi, 0xc00
  v_cndmask_b32 v225, 0, v8, vcc
  s_mov_b32 vcc_lo, 0x30
  s_mov_b32 vcc_hi, 0x3000
  v_cndmask_b32 v226, 0, v8, vcc
  s_mov_b32 vcc_lo, 0xc0
  s_mov_b32 vcc_hi, 0xc000
  v_cndmask_b32 v227, 0, v8, vcc
  s_mov_b32 vcc_lo, 0x30000
  s_mov_b32 vcc_hi, 0x3000000
  v_cndmask_b32 v228, 0, v8, vcc
  s_mov_b32 vcc_lo, 0xc0000
  s_mov_b32 vcc_hi, 0xc000000
  v_cndmask_b32 v229, 0, v8, vcc
  s_mov_b32 vcc_lo, 0x300000
  s_mov_b32 vcc_hi, 0x30000000
  v_cndmask_b32 v230, 0, v8, vcc
  s_mov_b32 vcc_lo, 0xc00000
  s_mov_b32 vcc_hi, 0xc0000000
  v_cndmask_b32 v231, 0, v8, vcc
  s_mov_b32 s28, s90
  s_mov_b32 s29, s91
  s_mov_b32 s30, 268435456
  s_mov_b32 s31, 0x20000
  s_mov_b32 s32, s58
  s_mov_b32 s33, s59
  s_mov_b32 s34, 524288
  s_mov_b32 s35, 0x20000
  s_mov_b64 s[0:1], s[64:65]
  s_mov_b32 s80, 0x409d30fc
  s_mov_b32 s81, 0x409d30fc
  s_mov_b32 s82, 0x3eeff558
  s_mov_b32 s83, 0x3eeff558
  s_mov_b32 s84, 0x3f803f80
  s_lshl_b32 s25, s5, 10
  s_add_u32 s25, s25, 65536
  s_lshl_b32 s27, s4, 11
  s_add_u32 s27, s27, 32768
  s_lshr_b32 s70, s5, 3
  s_and_b32 s71, s5, 7
  s_lshl_b32 s26, s70, 7
  s_lshl_b32 s79, s71, 2
  s_add_u32 s26, s26, s79
  s_add_u32 s26, s26, s27
  s_and_b32 s73, s4, 1
  s_cmp_lt_i32 s7, 0
  s_cselect_b32 s40, 64, -2
  s_add_u32 s40, s40, s7
  s_mul_i32 s41, s4, 196608
  s_mul_i32 s79, s3, 49152
  s_add_u32 s41, s41, s79
  s_add_u32 s41, s41, 15728640
  s_mul_i32 s37, s4, 196608
  s_lshl_b32 s79, s5, 10
  s_add_u32 s37, s37, s79
  s_mul_i32 s79, s3, 147456
  s_add_u32 s37, s37, s79
  s_add_u32 s37, s37, 15745024
  s_lshr_b32 s70, s5, 4
  s_and_b32 s71, s5, 15
  s_mul_i32 s70, s70, 49152
  s_lshl_b32 s79, s71, 10
  s_add_u32 s70, s70, s79
  s_mul_i32 s79, s4, 196608
  s_add_u32 s70, s70, s79
  s_add_u32 s70, s70, 15728640
  s_add_u32 s38, s37, 49152
  s_add_u32 s39, s37, 98304
  s_add_u32 s71, s70, 98304
  s_cmp_eq_u32 s3, 1
  s_cselect_b32 s38, s70, s38
  s_cselect_b32 s39, s71, s39
  s_lshl_b32 s70, s3, 10
  s_mul_i32 s79, s4, 196608
  s_add_u32 s70, s70, s79
  s_mul_i32 s79, s5, 6144
  s_add_u32 s70, s70, s79
  s_add_u32 s70, s70, 17299456
  s_cmp_ge_u32 s3, 2
  s_cselect_b32 s37, s70, s37
  s_add_u32 s70, s70, 2048
  s_add_u32 s71, s70, 2048
  s_cmp_ge_u32 s3, 2
  s_cselect_b32 s38, s70, s38
  s_cselect_b32 s39, s71, s39
  s_mul_i32 s42, s4, 266240
  s_mul_i32 s79, s5, 8320
  s_add_u32 s42, s42, s79
  s_add_u32 s42, s42, 11010048
  s_lshr_b32 s70, s5, 3
  s_and_b32 s71, s5, 7
  s_lshl_b32 s43, s70, 11
  s_lshl_b32 s79, s71, 7
  s_add_u32 s43, s43, s79
  s_mul_i32 s79, s4, 266240
  s_add_u32 s43, s43, s79
  s_add_u32 s43, s43, 11010048
  s_and_b32 s71, s3, 1
  s_lshr_b32 s70, s3, 1
  s_mul_i32 s72, s70, 4608
  s_lshl_b32 s79, s71, 11
  s_add_u32 s72, s72, s79
  s_add_u32 s72, s72, 147968
  s_lshl_b32 s46, s4, 4
  s_lshl_b32 s79, s3, 2
  s_add_u32 s46, s46, s79
  s_add_u32 s46, s46, s25
  s_mul_i32 s52, s5, 180224
  s_mul_i32 s79, s4, 11264
  s_add_u32 s52, s52, s79
  s_add_u32 s52, s52, 5242880
  s_lshl_b32 s48, s3, 11
  s_add_u32 s48, s48, s52
  s_add_u32 s49, s48, 90112
  s_waitcnt vmcnt(5)
  s_waitcnt lgkmcnt(0)
  s_bitcmp1_b32 s3, 1
  s_cselect_b32 s70, 0, 16
  s_lshl_b32 s66, s66, s70
  s_and_b32 s66, s66, 0xffff0000
  s_lshl_b32 s67, s67, s70
  s_and_b32 s67, s67, 0xffff0000
  v_mov_b32 v54, 0x3fb8aa3b
  v_mul_f32 v54, s66, v54
  v_exp_f32 v54, v54
  v_lshlrev_b32 v48, 16, v48
  v_lshlrev_b32 v49, 16, v49
  v_lshlrev_b32 v50, 16, v50
  v_lshlrev_b32 v51, 16, v51
  v_lshlrev_b32 v52, 16, v52
  v_lshlrev_b32 v53, 16, v53
  v_cvt_pk_bf16_f32 v54, v54, v54
  v_and_b32 v54, 0xffff0000, v54
  v_mul_f32 v48, v54, v48
  v_mul_f32 v49, v54, v49
  v_mul_f32 v50, v54, v50
  v_mul_f32 v51, v54, v51
  v_mul_f32 v192, 0x4138aa3b, v48
  v_mul_f32 v194, 0x3fb8aa3b, v48
  v_mul_f32 v196, 0x43b8aa3b, v48
  v_mul_f32 v193, 0x3fa2f983, v49
  v_mul_f32 v195, 0x3e22f983, v49
  v_mul_f32 v197, 0x4222f983, v49
  v_exp_f32 v192, v192
  v_exp_f32 v194, v194
  v_exp_f32 v196, v196
  v_fract_f32 v193, v193
  v_fract_f32 v195, v195
  v_fract_f32 v197, v197
  v_cos_f32 v66, v193
  v_cos_f32 v44, v195
  v_cos_f32 v46, v197
  v_sin_f32 v67, v193
  v_sin_f32 v45, v195
  v_sin_f32 v47, v197
  v_mul_f32 v66, v66, v192
  v_mul_f32 v44, v44, v194
  v_mul_f32 v46, v46, v196
  v_mul_f32 v67, v67, v192
  v_mul_f32 v45, v45, v194
  v_mul_f32 v47, v47, v196
  v_mov_b32 v64, 1.0
  v_mov_b32 v65, 0
  v_mov_b32 v16, v67
  v_mov_b32 v17, v66
  v_mov_b32 v18, v45
  v_mov_b32 v19, v44
  v_mov_b32 v20, v47
  v_mov_b32 v21, v46
  v_mov_b32 v22, v51
  v_mov_b32 v23, v50
  v_pk_mul_f32 v[68:69], v[66:67], v[66:67] op_sel_hi:[0,1]
  v_pk_mul_f32 v[128:129], v[52:53], v[50:51] op_sel_hi:[0,1]
  v_pk_fma_f32 v[68:69], v[66:67], v[16:17], v[68:69] op_sel:[1,0,0] neg_lo:[0,1,0]
  v_pk_fma_f32 v[128:129], v[52:53], v[22:23], v[128:129] op_sel:[1,0,0] neg_lo:[0,1,0]
  v_pk_mul_f32 v[70:71], v[68:69], v[66:67] op_sel_hi:[0,1]
  v_pk_mul_f32 v[130:131], v[128:129], v[44:45] op_sel_hi:[0,1]
  v_pk_fma_f32 v[70:71], v[68:69], v[16:17], v[70:71] op_sel:[1,0,0] neg_lo:[0,1,0]
  v_pk_fma_f32 v[130:131], v[128:129], v[18:19], v[130:131] op_sel:[1,0,0] neg_lo:[0,1,0]
  v_pk_mul_f32 v[72:73], v[70:71], v[66:67] op_sel_hi:[0,1]
  v_pk_mul_f32 v[132:133], v[130:131], v[44:45] op_sel_hi:[0,1]
  v_pk_fma_f32 v[72:73], v[70:71], v[16:17], v[72:73] op_sel:[1,0,0] neg_lo:[0,1,0]
  v_pk_fma_f32 v[132:133], v[130:131], v[18:19], v[132:133] op_sel:[1,0,0] neg_lo:[0,1,0]
  v_mov_b32 v24, v73
  v_pk_mul_f32 v[134:135], v[132:133], v[44:45] op_sel_hi:[0,1]
  v_mov_b32 v25, v72
  v_pk_fma_f32 v[134:135], v[132:133], v[18:19], v[134:135] op_sel:[1,0,0] neg_lo:[0,1,0]
  v_pk_mul_f32 v[74:75], v[66:67], v[72:73] op_sel_hi:[0,1]
  v_pk_mul_f32 v[136:137], v[134:135], v[44:45] op_sel_hi:[0,1]
  v_pk_mul_f32 v[76:77], v[68:69], v[72:73] op_sel_hi:[0,1]
  v_pk_fma_f32 v[136:137], v[134:135], v[18:19], v[136:137] op_sel:[1,0,0] neg_lo:[0,1,0]
  v_pk_mul_f32 v[78:79], v[70:71], v[72:73] op_sel_hi:[0,1]
  v_pk_mul_f32 v[138:139], v[136:137], v[44:45] op_sel_hi:[0,1]
  v_pk_mul_f32 v[80:81], v[72:73], v[72:73] op_sel_hi:[0,1]
  v_pk_fma_f32 v[138:139], v[136:137], v[18:19], v[138:139] op_sel:[1,0,0] neg_lo:[0,1,0]
  v_pk_fma_f32 v[74:75], v[66:67], v[24:25], v[74:75] op_sel:[1,0,0] neg_lo:[0,1,0]
  v_pk_mul_f32 v[140:141], v[138:139], v[44:45] op_sel_hi:[0,1]
  v_pk_fma_f32 v[76:77], v[68:69], v[24:25], v[76:77] op_sel:[1,0,0] neg_lo:[0,1,0]
  v_pk_fma_f32 v[140:141], v[138:139], v[18:19], v[140:141] op_sel:[1,0,0] neg_lo:[0,1,0]
  v_pk_fma_f32 v[78:79], v[70:71], v[24:25], v[78:79] op_sel:[1,0,0] neg_lo:[0,1,0]
  v_pk_mul_f32 v[142:143], v[140:141], v[44:45] op_sel_hi:[0,1]
  v_pk_fma_f32 v[80:81], v[72:73], v[24:25], v[80:81] op_sel:[1,0,0] neg_lo:[0,1,0]
  v_pk_fma_f32 v[142:143], v[140:141], v[18:19], v[142:143] op_sel:[1,0,0] neg_lo:[0,1,0]
  v_pk_mul_f32 v[82:83], v[74:75], v[72:73] op_sel_hi:[0,1]
  v_pk_mul_f32 v[144:145], v[142:143], v[44:45] op_sel_hi:[0,1]
  v_pk_mul_f32 v[84:85], v[76:77], v[72:73] op_sel_hi:[0,1]
  v_pk_fma_f32 v[144:145], v[142:143], v[18:19], v[144:145] op_sel:[1,0,0] neg_lo:[0,1,0]
  v_pk_mul_f32 v[86:87], v[78:79], v[72:73] op_sel_hi:[0,1]
  v_pk_mul_f32 v[146:147], v[128:129], v[46:47] op_sel_hi:[0,1]
  v_pk_mul_f32 v[88:89], v[80:81], v[72:73] op_sel_hi:[0,1]
  v_pk_mul_f32 v[148:149], v[132:133], v[46:47] op_sel_hi:[0,1]
  v_pk_fma_f32 v[82:83], v[74:75], v[24:25], v[82:83] op_sel:[1,0,0] neg_lo:[0,1,0]
  v_pk_mul_f32 v[150:151], v[136:137], v[46:47] op_sel_hi:[0,1]
  v_pk_fma_f32 v[84:85], v[76:77], v[24:25], v[84:85] op_sel:[1,0,0] neg_lo:[0,1,0]
  v_pk_mul_f32 v[152:153], v[140:141], v[46:47] op_sel_hi:[0,1]
  v_pk_fma_f32 v[86:87], v[78:79], v[24:25], v[86:87] op_sel:[1,0,0] neg_lo:[0,1,0]
  v_pk_mul_f32 v[154:155], v[144:145], v[46:47] op_sel_hi:[0,1]
  v_pk_fma_f32 v[88:89], v[80:81], v[24:25], v[88:89] op_sel:[1,0,0] neg_lo:[0,1,0]
  v_pk_fma_f32 v[146:147], v[128:129], v[20:21], v[146:147] op_sel:[1,0,0] neg_lo:[0,1,0]
  v_pk_mul_f32 v[90:91], v[82:83], v[72:73] op_sel_hi:[0,1]
  v_pk_fma_f32 v[148:149], v[132:133], v[20:21], v[148:149] op_sel:[1,0,0] neg_lo:[0,1,0]
  v_pk_mul_f32 v[92:93], v[84:85], v[72:73] op_sel_hi:[0,1]
  v_pk_fma_f32 v[150:151], v[136:137], v[20:21], v[150:151] op_sel:[1,0,0] neg_lo:[0,1,0]
  v_pk_mul_f32 v[94:95], v[86:87], v[72:73] op_sel_hi:[0,1]
  v_pk_fma_f32 v[152:153], v[140:141], v[20:21], v[152:153] op_sel:[1,0,0] neg_lo:[0,1,0]
  v_pk_mul_f32 v[96:97], v[88:89], v[72:73] op_sel_hi:[0,1]
  v_pk_fma_f32 v[154:155], v[144:145], v[20:21], v[154:155] op_sel:[1,0,0] neg_lo:[0,1,0]
  v_pk_fma_f32 v[90:91], v[82:83], v[24:25], v[90:91] op_sel:[1,0,0] neg_lo:[0,1,0]
  v_pk_mul_f32 v[156:157], v[146:147], v[46:47] op_sel_hi:[0,1]
  v_pk_fma_f32 v[92:93], v[84:85], v[24:25], v[92:93] op_sel:[1,0,0] neg_lo:[0,1,0]
  v_pk_mul_f32 v[158:159], v[150:151], v[46:47] op_sel_hi:[0,1]
  v_pk_fma_f32 v[94:95], v[86:87], v[24:25], v[94:95] op_sel:[1,0,0] neg_lo:[0,1,0]
  v_pk_mul_f32 v[160:161], v[154:155], v[46:47] op_sel_hi:[0,1]
  v_pk_fma_f32 v[96:97], v[88:89], v[24:25], v[96:97] op_sel:[1,0,0] neg_lo:[0,1,0]
  v_pk_fma_f32 v[156:157], v[146:147], v[20:21], v[156:157] op_sel:[1,0,0] neg_lo:[0,1,0]
  v_pk_mul_f32 v[98:99], v[90:91], v[72:73] op_sel_hi:[0,1]
  v_pk_fma_f32 v[158:159], v[150:151], v[20:21], v[158:159] op_sel:[1,0,0] neg_lo:[0,1,0]
  v_pk_mul_f32 v[100:101], v[92:93], v[72:73] op_sel_hi:[0,1]
  v_pk_fma_f32 v[160:161], v[154:155], v[20:21], v[160:161] op_sel:[1,0,0] neg_lo:[0,1,0]
  v_pk_mul_f32 v[102:103], v[94:95], v[72:73] op_sel_hi:[0,1]
  v_pk_mul_f32 v[162:163], v[156:157], v[46:47] op_sel_hi:[0,1]
  v_pk_mul_f32 v[104:105], v[96:97], v[72:73] op_sel_hi:[0,1]
  v_pk_mul_f32 v[164:165], v[158:159], v[46:47] op_sel_hi:[0,1]
  v_pk_fma_f32 v[98:99], v[90:91], v[24:25], v[98:99] op_sel:[1,0,0] neg_lo:[0,1,0]
  v_pk_mul_f32 v[166:167], v[160:161], v[46:47] op_sel_hi:[0,1]
  v_pk_fma_f32 v[100:101], v[92:93], v[24:25], v[100:101] op_sel:[1,0,0] neg_lo:[0,1,0]
  v_pk_fma_f32 v[162:163], v[156:157], v[20:21], v[162:163] op_sel:[1,0,0] neg_lo:[0,1,0]
  v_pk_fma_f32 v[102:103], v[94:95], v[24:25], v[102:103] op_sel:[1,0,0] neg_lo:[0,1,0]
  v_pk_fma_f32 v[164:165], v[158:159], v[20:21], v[164:165] op_sel:[1,0,0] neg_lo:[0,1,0]
  v_pk_fma_f32 v[104:105], v[96:97], v[24:25], v[104:105] op_sel:[1,0,0] neg_lo:[0,1,0]
  v_pk_fma_f32 v[166:167], v[160:161], v[20:21], v[166:167] op_sel:[1,0,0] neg_lo:[0,1,0]
  v_pk_mul_f32 v[106:107], v[98:99], v[72:73] op_sel_hi:[0,1]
  v_pk_mul_f32 v[168:169], v[162:163], v[46:47] op_sel_hi:[0,1]
  v_pk_mul_f32 v[108:109], v[100:101], v[72:73] op_sel_hi:[0,1]
  v_pk_mul_f32 v[170:171], v[166:167], v[46:47] op_sel_hi:[0,1]
  v_pk_mul_f32 v[110:111], v[102:103], v[72:73] op_sel_hi:[0,1]
  v_pk_fma_f32 v[168:169], v[162:163], v[20:21], v[168:169] op_sel:[1,0,0] neg_lo:[0,1,0]
  v_pk_mul_f32 v[112:113], v[104:105], v[72:73] op_sel_hi:[0,1]
  v_pk_fma_f32 v[170:171], v[166:167], v[20:21], v[170:171] op_sel:[1,0,0] neg_lo:[0,1,0]
  v_pk_fma_f32 v[106:107], v[98:99], v[24:25], v[106:107] op_sel:[1,0,0] neg_lo:[0,1,0]
  v_pk_mul_f32 v[172:173], v[168:169], v[46:47] op_sel_hi:[0,1]
  v_pk_fma_f32 v[108:109], v[100:101], v[24:25], v[108:109] op_sel:[1,0,0] neg_lo:[0,1,0]
  v_pk_mul_f32 v[174:175], v[170:171], v[46:47] op_sel_hi:[0,1]
  v_pk_fma_f32 v[110:111], v[102:103], v[24:25], v[110:111] op_sel:[1,0,0] neg_lo:[0,1,0]
  v_pk_fma_f32 v[172:173], v[168:169], v[20:21], v[172:173] op_sel:[1,0,0] neg_lo:[0,1,0]
  v_pk_fma_f32 v[112:113], v[104:105], v[24:25], v[112:113] op_sel:[1,0,0] neg_lo:[0,1,0]
  v_pk_fma_f32 v[174:175], v[170:171], v[20:21], v[174:175] op_sel:[1,0,0] neg_lo:[0,1,0]
  v_pk_mul_f32 v[114:115], v[106:107], v[72:73] op_sel_hi:[0,1]
  v_pk_mul_f32 v[176:177], v[172:173], v[46:47] op_sel_hi:[0,1]
  v_pk_mul_f32 v[116:117], v[108:109], v[72:73] op_sel_hi:[0,1]
  v_pk_mul_f32 v[178:179], v[174:175], v[46:47] op_sel_hi:[0,1]
  v_pk_mul_f32 v[118:119], v[110:111], v[72:73] op_sel_hi:[0,1]
  v_pk_fma_f32 v[176:177], v[172:173], v[20:21], v[176:177] op_sel:[1,0,0] neg_lo:[0,1,0]
  v_pk_mul_f32 v[120:121], v[112:113], v[72:73] op_sel_hi:[0,1]
  v_pk_fma_f32 v[178:179], v[174:175], v[20:21], v[178:179] op_sel:[1,0,0] neg_lo:[0,1,0]
  v_pk_fma_f32 v[114:115], v[106:107], v[24:25], v[114:115] op_sel:[1,0,0] neg_lo:[0,1,0]
  v_pk_mul_f32 v[180:181], v[176:177], v[46:47] op_sel_hi:[0,1]
  v_pk_fma_f32 v[116:117], v[108:109], v[24:25], v[116:117] op_sel:[1,0,0] neg_lo:[0,1,0]
  v_pk_mul_f32 v[182:183], v[178:179], v[46:47] op_sel_hi:[0,1]
  v_pk_fma_f32 v[118:119], v[110:111], v[24:25], v[118:119] op_sel:[1,0,0] neg_lo:[0,1,0]
  v_pk_fma_f32 v[180:181], v[176:177], v[20:21], v[180:181] op_sel:[1,0,0] neg_lo:[0,1,0]
  v_pk_fma_f32 v[120:121], v[112:113], v[24:25], v[120:121] op_sel:[1,0,0] neg_lo:[0,1,0]
  v_pk_fma_f32 v[182:183], v[178:179], v[20:21], v[182:183] op_sel:[1,0,0] neg_lo:[0,1,0]
  v_pk_mul_f32 v[122:123], v[114:115], v[72:73] op_sel_hi:[0,1]
  v_pk_mul_f32 v[124:125], v[116:117], v[72:73] op_sel_hi:[0,1]
  v_pk_mul_f32 v[126:127], v[118:119], v[72:73] op_sel_hi:[0,1]
  v_pk_fma_f32 v[122:123], v[114:115], v[24:25], v[122:123] op_sel:[1,0,0] neg_lo:[0,1,0]
  v_pk_fma_f32 v[124:125], v[116:117], v[24:25], v[124:125] op_sel:[1,0,0] neg_lo:[0,1,0]
  v_pk_fma_f32 v[126:127], v[118:119], v[24:25], v[126:127] op_sel:[1,0,0] neg_lo:[0,1,0]
  v_cvt_pk_bf16_f32 v192, v64, v66
  v_cvt_pk_bf16_f32 v193, v68, v70
  v_cvt_pk_bf16_f32 v194, v72, v74
  v_cvt_pk_bf16_f32 v195, v76, v78
  v_cvt_pk_bf16_f32 v196, v80, v82
  v_cvt_pk_bf16_f32 v197, v84, v86
  v_cvt_pk_bf16_f32 v198, v88, v90
  v_cvt_pk_bf16_f32 v199, v92, v94
  v_cvt_pk_bf16_f32 v200, v96, v98
  v_cvt_pk_bf16_f32 v201, v100, v102
  v_cvt_pk_bf16_f32 v202, v104, v106
  v_cvt_pk_bf16_f32 v203, v108, v110
  v_cvt_pk_bf16_f32 v204, v112, v114
  v_cvt_pk_bf16_f32 v205, v116, v118
  v_cvt_pk_bf16_f32 v206, v120, v122
  v_cvt_pk_bf16_f32 v207, v124, v126
  v_permlane32_swap_b32 v192, v196
  v_permlane32_swap_b32 v193, v197
  v_permlane32_swap_b32 v194, v198
  v_permlane32_swap_b32 v195, v199
  v_permlane32_swap_b32 v200, v204
  v_permlane32_swap_b32 v201, v205
  v_permlane32_swap_b32 v202, v206
  v_permlane32_swap_b32 v203, v207
  v_cvt_pk_bf16_f32 v208, v65, v67
  v_cvt_pk_bf16_f32 v209, v69, v71
  v_cvt_pk_bf16_f32 v210, v73, v75
  v_cvt_pk_bf16_f32 v211, v77, v79
  v_cvt_pk_bf16_f32 v212, v81, v83
  v_cvt_pk_bf16_f32 v213, v85, v87
  v_cvt_pk_bf16_f32 v214, v89, v91
  v_cvt_pk_bf16_f32 v215, v93, v95
  v_cvt_pk_bf16_f32 v216, v97, v99
  v_cvt_pk_bf16_f32 v217, v101, v103
  v_cvt_pk_bf16_f32 v218, v105, v107
  v_cvt_pk_bf16_f32 v219, v109, v111
  v_cvt_pk_bf16_f32 v220, v113, v115
  v_cvt_pk_bf16_f32 v221, v117, v119
  v_cvt_pk_bf16_f32 v222, v121, v123
  v_cvt_pk_bf16_f32 v223, v125, v127
  v_permlane32_swap_b32 v208, v212
  v_permlane32_swap_b32 v209, v213
  v_permlane32_swap_b32 v210, v214
  v_permlane32_swap_b32 v211, v215
  v_permlane32_swap_b32 v216, v220
  v_permlane32_swap_b32 v217, v221
  v_permlane32_swap_b32 v218, v222
  v_permlane32_swap_b32 v219, v223
  v_mfma_f32_32x32x16_bf16 v[96:111], v[192:195], v[224:227], 0
  v_mfma_f32_32x32x16_bf16 v[96:111], v[200:203], v[228:231], v[96:111]
  v_mfma_f32_32x32x16_bf16 v[112:127], v[196:199], v[224:227], 0
  v_mfma_f32_32x32x16_bf16 v[112:127], v[204:207], v[228:231], v[112:127]
  v_mfma_f32_32x32x16_bf16 v[16:31], v[208:211], v[224:227], 0
  v_cvt_pk_bf16_f32 v192, v128, v130
  v_cvt_pk_bf16_f32 v193, v132, v134
  v_cvt_pk_bf16_f32 v194, v146, v146
  v_cvt_pk_bf16_f32 v195, v148, v150
  v_cvt_pk_bf16_f32 v196, v136, v138
  v_cvt_pk_bf16_f32 v197, v140, v142
  v_mfma_f32_32x32x16_bf16 v[16:31], v[216:219], v[228:231], v[16:31]
  v_cvt_pk_bf16_f32 v198, v150, v150
  v_cvt_pk_bf16_f32 v199, v152, v154
  v_cvt_pk_bf16_f32 v200, v144, v156
  v_cvt_pk_bf16_f32 v201, v158, v160
  v_cvt_pk_bf16_f32 v202, v154, v162
  v_cvt_pk_bf16_f32 v203, v164, v166
  v_mfma_f32_32x32x16_bf16 v[32:47], v[212:215], v[224:227], 0
  v_cvt_pk_bf16_f32 v204, v168, v170
  v_cvt_pk_bf16_f32 v205, v176, v178
  v_cvt_pk_bf16_f32 v206, v172, v174
  v_cvt_pk_bf16_f32 v207, v180, v182
  v_permlane32_swap_b32 v192, v196
  v_permlane32_swap_b32 v193, v197
  v_mfma_f32_32x32x16_bf16 v[32:47], v[220:223], v[228:231], v[32:47]
  v_permlane32_swap_b32 v194, v198
  v_permlane32_swap_b32 v195, v199
  v_permlane32_swap_b32 v200, v204
  v_permlane32_swap_b32 v201, v205
  v_permlane32_swap_b32 v202, v206
  v_permlane32_swap_b32 v203, v207
  v_cvt_pk_bf16_f32 v64, v96, v97
  v_cvt_pk_bf16_f32 v65, v98, v99
  v_cvt_pk_bf16_f32 v66, v100, v101
  v_cvt_pk_bf16_f32 v67, v102, v103
  v_cvt_pk_bf16_f32 v68, v104, v105
  v_cvt_pk_bf16_f32 v69, v106, v107
  v_cvt_pk_bf16_f32 v70, v108, v109
  v_cvt_pk_bf16_f32 v71, v110, v111
  v_cvt_pk_bf16_f32 v72, v112, v113
  v_cvt_pk_bf16_f32 v73, v114, v115
  v_cvt_pk_bf16_f32 v74, v116, v117
  v_cvt_pk_bf16_f32 v75, v118, v119
  v_cvt_pk_bf16_f32 v76, v120, v121
  v_cvt_pk_bf16_f32 v77, v122, v123
  v_cvt_pk_bf16_f32 v78, v124, v125
  v_cvt_pk_bf16_f32 v79, v126, v127
  v_mfma_f32_32x32x16_bf16 v[96:111], v[192:195], v[224:227], 0
  v_cvt_pk_bf16_f32 v208, -v129, -v131
  v_cvt_pk_bf16_f32 v209, -v133, -v135
  v_cvt_pk_bf16_f32 v210, -v147, -v147
  v_cvt_pk_bf16_f32 v211, -v149, -v151
  v_cvt_pk_bf16_f32 v212, -v137, -v139
  v_cvt_pk_bf16_f32 v213, -v141, -v143
  v_cvt_pk_bf16_f32 v214, -v151, -v151
  v_cvt_pk_bf16_f32 v215, -v153, -v155
  v_cvt_pk_bf16_f32 v216, -v145, -v157
  v_cvt_pk_bf16_f32 v217, -v159, -v161
  v_mfma_f32_32x32x16_bf16 v[96:111], v[200:203], v[228:231], v[96:111]
  v_cvt_pk_bf16_f32 v218, -v155, -v163
  v_cvt_pk_bf16_f32 v219, -v165, -v167
  v_cvt_pk_bf16_f32 v220, -v169, -v171
  v_cvt_pk_bf16_f32 v221, -v177, -v179
  v_cvt_pk_bf16_f32 v222, -v173, -v175
  v_cvt_pk_bf16_f32 v223, -v181, -v183
  v_permlane32_swap_b32 v208, v212
  v_permlane32_swap_b32 v209, v213
  v_permlane32_swap_b32 v210, v214
  v_permlane32_swap_b32 v211, v215
  v_mfma_f32_32x32x16_bf16 v[112:127], v[196:199], v[224:227], 0
  v_permlane32_swap_b32 v216, v220
  v_permlane32_swap_b32 v217, v221
  v_permlane32_swap_b32 v218, v222
  v_permlane32_swap_b32 v219, v223
  v_cvt_pk_bf16_f32 v80, v16, v17
  v_cvt_pk_bf16_f32 v81, v18, v19
  v_cvt_pk_bf16_f32 v82, v20, v21
  v_cvt_pk_bf16_f32 v83, v22, v23
  v_cvt_pk_bf16_f32 v84, v24, v25
  v_cvt_pk_bf16_f32 v85, v26, v27
  v_mfma_f32_32x32x16_bf16 v[112:127], v[204:207], v[228:231], v[112:127]
  v_cvt_pk_bf16_f32 v86, v28, v29
  v_cvt_pk_bf16_f32 v87, v30, v31
  v_cvt_pk_bf16_f32 v88, v32, v33
  v_cvt_pk_bf16_f32 v89, v34, v35
  v_cvt_pk_bf16_f32 v90, v36, v37
  v_cvt_pk_bf16_f32 v91, v38, v39
  v_cvt_pk_bf16_f32 v92, v40, v41
  v_cvt_pk_bf16_f32 v93, v42, v43
  v_cvt_pk_bf16_f32 v94, v44, v45
  v_cvt_pk_bf16_f32 v95, v46, v47
  v_mfma_f32_32x32x16_bf16 v[16:31], v[208:211], v[224:227], 0
  v_mfma_f32_32x32x16_bf16 v[16:31], v[216:219], v[228:231], v[16:31]
  v_mfma_f32_32x32x16_bf16 v[32:47], v[212:215], v[224:227], 0
  v_mfma_f32_32x32x16_bf16 v[32:47], v[220:223], v[228:231], v[32:47]
  v_cvt_pk_bf16_f32 v128, v96, v97
  v_cvt_pk_bf16_f32 v129, v98, v99
  v_cvt_pk_bf16_f32 v130, v100, v101
  v_cvt_pk_bf16_f32 v131, v102, v103
  v_cvt_pk_bf16_f32 v132, v104, v105
  v_cvt_pk_bf16_f32 v133, v106, v107
  v_cvt_pk_bf16_f32 v134, v108, v109
  v_cvt_pk_bf16_f32 v135, v110, v111
  v_cvt_pk_bf16_f32 v136, v112, v113
  v_cvt_pk_bf16_f32 v137, v114, v115
  v_cvt_pk_bf16_f32 v138, v116, v117
  v_cvt_pk_bf16_f32 v139, v118, v119
  v_cvt_pk_bf16_f32 v140, v120, v121
  v_cvt_pk_bf16_f32 v141, v122, v123
  v_cvt_pk_bf16_f32 v142, v124, v125
  v_cvt_pk_bf16_f32 v143, v126, v127
  v_cvt_pk_bf16_f32 v144, v16, v17
  v_cvt_pk_bf16_f32 v145, v18, v19
  v_cvt_pk_bf16_f32 v146, v20, v21
  v_cvt_pk_bf16_f32 v147, v22, v23
  v_cvt_pk_bf16_f32 v148, v24, v25
  v_cvt_pk_bf16_f32 v149, v26, v27
  v_cvt_pk_bf16_f32 v150, v28, v29
  v_cvt_pk_bf16_f32 v151, v30, v31
  v_cvt_pk_bf16_f32 v152, v32, v33
  v_cvt_pk_bf16_f32 v153, v34, v35
  v_cvt_pk_bf16_f32 v154, v36, v37
  v_cvt_pk_bf16_f32 v155, v38, v39
  v_cvt_pk_bf16_f32 v156, v40, v41
  v_cvt_pk_bf16_f32 v157, v42, v43
  v_cvt_pk_bf16_f32 v158, v44, v45
  v_cvt_pk_bf16_f32 v159, v46, v47
  v_mfma_f32_32x32x16_bf16 v[192:207], v[128:131], v[64:67], 0
  s_lshl_b32 s70, s3, 12
  v_add_u32 v39, s70, v4
  v_xor_b32 v40, 0x1000, v39
  s_lshl_b32 s70, s7, 3
  s_add_u32 s70, s70, 27920
  v_mfma_f32_32x32x16_bf16 v[192:207], v[132:135], v[68:71], v[192:207]
  v_lshl_add_u32 v43, v0, 3, s70
  s_mul_i32 s60, s75, 8320
  s_add_u32 s70, s60, 1008
  v_sub_u32 v28, s70, v4
  s_add_u32 s70, s60, 4160
  v_mfma_f32_32x32x16_bf16 v[192:207], v[136:139], v[72:75], v[192:207]
  v_bfe_u32 v12, v0, 3, 1
  v_mul_u32_u24 v29, 4160, v12
  v_sub_u32 v29, s70, v29
  v_and_b32 v13, 7, v0
  v_lshl_add_u32 v29, v13, 2, v29
  v_mfma_f32_32x32x16_bf16 v[192:207], v[140:143], v[76:79], v[192:207]
  s_lshl_b32 s70, s3, 12
  v_lshrrev_b32 v14, 5, v0
  v_lshl_add_u32 v31, v14, 8, s70
  v_bfe_u32 v15, v0, 2, 2
  v_lshl_add_u32 v31, v15, 6, v31
  v_mfma_f32_32x32x16_bf16 v[192:207], v[144:147], v[80:83], v[192:207]
  v_bfe_u32 v16, v0, 4, 1
  v_lshl_add_u32 v31, v16, 5, v31
  v_and_b32 v17, 3, v0
  v_lshl_add_u32 v31, v17, 3, v31
  v_lshlrev_b32 v34, 10, v14
  v_mfma_f32_32x32x16_bf16 v[192:207], v[148:151], v[84:87], v[192:207]
  v_and_b32 v18, 31, v0
  v_lshl_add_u32 v34, v18, 2, v34
  v_add_u32 v34, 24832, v34
  v_lshlrev_b32 v46, 6, v16
  v_xor_b32 v41, v60, v46
  v_mfma_f32_32x32x16_bf16 v[192:207], v[152:155], v[88:91], v[192:207]
  s_lshl_b32 s70, s3, 5
  v_lshrrev_b32 v19, 4, v0
  v_lshl_add_u32 v35, v19, 10, s70
  v_lshl_add_u32 v35, v15, 7, v35
  v_lshl_add_u32 v35, v17, 3, v35
  v_mfma_f32_32x32x16_bf16 v[192:207], v[156:159], v[92:95], v[192:207]
  v_lshlrev_b32 v36, 6, v19
  s_lshl_b32 s70, s3, 11
  v_and_b32 v20, 15, v0
  v_lshl_add_u32 v37, v20, 6, s70
  v_lshl_add_u32 v37, v19, 4, v37
  s_add_u32 s68, s68, 1
  s_mov_b32 s69, s68
  s_getreg_b32 s36, hwreg(HW_REG_XCC_ID, 0, 4)
  s_lshl_b32 s36, s36, 28
  s_add_u32 s36, s36, s68
  s_waitcnt vmcnt(0)
  s_cmp_ge_u32 s3, 2
  s_cbranch_scc1 FM_55
  ds_write_b128 v39, v[240:243] offset:0
  ds_write_b128 v39, v[244:247] offset:1024
  ds_write_b128 v39, v[248:251] offset:2048
  ds_read_b64_tr_b16 v[112:113], v31 offset:0
  ds_read_b64_tr_b16 v[114:115], v31 offset:512
  ds_read_b64_tr_b16 v[116:117], v31 offset:1024
  ds_read_b64_tr_b16 v[118:119], v31 offset:1536
  ds_read_b64_tr_b16 v[120:121], v31 offset:2048
  ds_read_b64_tr_b16 v[122:123], v31 offset:2560
  s_waitcnt lgkmcnt(0)
  buffer_store_dwordx4 v[112:115], v4, s[28:31], s37 offen sc1
  buffer_store_dwordx4 v[116:119], v4, s[28:31], s38 offen sc1
  buffer_store_dwordx4 v[120:123], v4, s[28:31], s39 offen sc1
  s_mov_b32 s37, 0x80000000
  s_mov_b32 s38, 0x80000000
  s_mov_b32 s39, 0x80000000
  s_branch FM_56
FM_55:
  s_cmp_lg_u32 s3, 3
  s_cbranch_scc1 FM_56
  s_lshl_b32 s70, s4, 2
  s_add_u32 s70, s70, s25
  v_mov_b32 v3, s36
  s_mov_b64 exec, 1
  buffer_store_dword v3, off, s[28:31], s70 offset:768 sc1
  s_mov_b64 exec, -1
  v_mov_b32 v12, 0
  v_mov_b32 v13, 0
  v_mov_b32 v14, 0
  v_mov_b32 v15, 0
  v_lshlrev_b32 v16, 16, v232
  v_and_b32 v17, 0xffff0000, v232
  v_add_f32 v12, v12, v16
  v_fmac_f32 v13, v16, v16
  v_add_f32 v14, v14, v17
  v_fmac_f32 v15, v17, v17
  v_lshlrev_b32 v16, 16, v233
  v_and_b32 v17, 0xffff0000, v233
  v_add_f32 v12, v12, v16
  v_fmac_f32 v13, v16, v16
  v_add_f32 v14, v14, v17
  v_fmac_f32 v15, v17, v17
  v_lshlrev_b32 v16, 16, v234
  v_and_b32 v17, 0xffff0000, v234
  v_add_f32 v12, v12, v16
  v_fmac_f32 v13, v16, v16
  v_add_f32 v14, v14, v17
  v_fmac_f32 v15, v17, v17
  v_lshlrev_b32 v16, 16, v235
  v_and_b32 v17, 0xffff0000, v235
  v_add_f32 v12, v12, v16
  v_fmac_f32 v13, v16, v16
  v_add_f32 v14, v14, v17
  v_fmac_f32 v15, v17, v17
  v_lshlrev_b32 v16, 16, v236
  v_and_b32 v17, 0xffff0000, v236
  v_add_f32 v12, v12, v16
  v_fmac_f32 v13, v16, v16
  v_add_f32 v14, v14, v17
  v_fmac_f32 v15, v17, v17
  v_lshlrev_b32 v16, 16, v237
  v_and_b32 v17, 0xffff0000, v237
  v_add_f32 v12, v12, v16
  v_fmac_f32 v13, v16, v16
  v_add_f32 v14, v14, v17
  v_fmac_f32 v15, v17, v17
  v_lshlrev_b32 v16, 16, v238
  v_and_b32 v17, 0xffff0000, v238
  v_add_f32 v12, v12, v16
  v_fmac_f32 v13, v16, v16
  v_add_f32 v14, v14, v17
  v_fmac_f32 v15, v17, v17
  v_lshlrev_b32 v16, 16, v239
  v_and_b32 v17, 0xffff0000, v239
  v_add_f32 v12, v12, v16
  v_fmac_f32 v13, v16, v16
  v_add_f32 v14, v14, v17
  v_fmac_f32 v15, v17, v17
  v_add_f32 v12, v12, v14
  v_add_f32 v13, v13, v15
  s_nop 1
  v_permlane16_swap_b32 v12, v13
  v_add_f32 v12, v12, v13
  s_nop 1
  v_add_f32_dpp v12, v12, v12 row_ror:8 row_mask:0xf bank_mask:0xf
  s_nop 1
  v_add_f32_dpp v12, v12, v12 row_ror:4 row_mask:0xf bank_mask:0xf
  s_nop 1
  v_add_f32_dpp v12, v12, v12 row_ror:2 row_mask:0xf bank_mask:0xf
  s_nop 1
  v_add_f32_dpp v12, v12, v12 row_ror:1 row_mask:0xf bank_mask:0xf
  v_mov_b32 v13, v12
  s_nop 1
  v_permlane16_swap_b32 v12, v13
  v_mul_f32 v12, 0x3b000000, v12
  v_mul_f32 v13, 0x3b000000, v13
  v_fma_f32 v13, -v12, v12, v13
  v_max_f32 v13, 0, v13
  v_add_f32 v13, 0x3727c5ac, v13
  v_rsq_f32 v13, v13
  s_lshl_b32 s70, s40, 3
  s_add_u32 s70, s70, 27920
  v_lshrrev_b32 v14, 5, v0
  v_lshl_add_u32 v14, v14, 3, s70
  s_mov_b32 exec_lo, 1
  s_mov_b32 exec_hi, 1
  ds_write_b64 v14, v[12:13]
  s_mov_b64 exec, -1
FM_56:
  s_setprio 3
  s_mov_b64 exec, 1
  ds_add_u32 v1, v2 offset:30016
  s_mov_b64 exec, -1
  s_cmp_ge_u32 s3, 2
  s_cbranch_scc1 FF_57
  s_waitcnt vmcnt(0)
  s_mov_b64 exec, 1
  ds_add_rtn_u32 v3, v1, v2 offset:30104
  s_waitcnt lgkmcnt(0)
  v_readfirstlane_b32 s78, v3
  s_nop 0
  s_cmp_eq_u32 s78, 1
  s_cbranch_scc0 PB_58
  v_mov_b32 v3, s68
  buffer_store_dword v3, off, s[28:31], s26 offset:0 sc1
PB_58:
  s_mov_b64 exec, -1
FF_57:
  s_mov_b32 s79, 1000000
SP_59:
  ds_read_b32 v3, v1 offset:30016
  s_waitcnt lgkmcnt(0)
  v_readfirstlane_b32 s78, v3
  s_nop 0
  s_cmp_ge_u32 s78, 8
  s_cbranch_scc1 SPE_60
  s_sub_u32 s79, s79, 1
  s_cbranch_scc0 SP_59
SPE_60:
  s_mov_b32 s79, 1000000
SP_61:
  ds_read_b32 v3, v1 offset:30040
  s_waitcnt lgkmcnt(0)
  v_readfirstlane_b32 s78, v3
  s_nop 0
  s_cmp_ge_u32 s78, 4
  s_cbranch_scc1 SPE_62
  s_sub_u32 s79, s79, 1
  s_cbranch_scc0 SP_61
SPE_62:
  s_lshl_b32 s77, s3, 17
  s_lshl_b32 s79, s4, 7
  s_add_u32 s77, s77, s79
  s_lshl_b32 s71, s3, 14
  s_add_u32 s71, s71, 98304
  s_mov_b32 m0, s71
  s_nop 0
  buffer_load_dwordx4 v41, s[32:35], s77 offen lds
  s_addk_i32 m0, 1024
  s_addk_i32 s77, 8192
  buffer_load_dwordx4 v41, s[32:35], s77 offen lds
  s_addk_i32 m0, 1024
  s_addk_i32 s77, 8192
  buffer_load_dwordx4 v41, s[32:35], s77 offen lds
  s_addk_i32 m0, 1024
  s_addk_i32 s77, 8192
  buffer_load_dwordx4 v41, s[32:35], s77 offen lds
  s_addk_i32 m0, 1024
  s_addk_i32 s77, 8192
  buffer_load_dwordx4 v41, s[32:35], s77 offen lds
  s_addk_i32 m0, 1024
  s_addk_i32 s77, 8192
  buffer_load_dwordx4 v41, s[32:35], s77 offen lds
  s_addk_i32 m0, 1024
  s_addk_i32 s77, 8192
  buffer_load_dwordx4 v41, s[32:35], s77 offen lds
  s_addk_i32 m0, 1024
  s_addk_i32 s77, 8192
  buffer_load_dwordx4 v41, s[32:35], s77 offen lds
  ds_read2_b32 v[12:13], v34 offset0:0 offset1:32
  ds_read2_b32 v[14:15], v34 offset0:64 offset1:96
  ds_read2_b32 v[16:17], v34 offset0:128 offset1:160
  ds_read2_b32 v[18:19], v34 offset0:192 offset1:224
  ds_read_b64_tr_b16 v[128:129], v35 offset:16640
  ds_read_b64_tr_b16 v[130:131], v35 offset:17152
  ds_read_b64_tr_b16 v[132:133], v35 offset:20736
  ds_read_b64_tr_b16 v[134:135], v35 offset:21248
  ds_read_b64_tr_b16 v[112:113], v31 offset:0
  ds_read_b64_tr_b16 v[114:115], v31 offset:512
  ds_read_b64_tr_b16 v[116:117], v31 offset:1024
  ds_read_b64_tr_b16 v[118:119], v31 offset:1536
  ds_read_b64_tr_b16 v[120:121], v31 offset:2048
  ds_read_b64_tr_b16 v[122:123], v31 offset:2560
  s_waitcnt lgkmcnt(10)
  v_add_f32 v12, v12, v16
  v_add_f32 v13, v13, v17
  v_add_f32 v14, v14, v18
  v_add_f32 v15, v15, v19
  v_add_f32 v12, v12, v14
  v_add_f32 v13, v13, v15
  v_mul_f32 v12, 0x3b000000, v12
  v_mul_f32 v13, 0x3b000000, v13
  v_fma_f32 v13, -v12, v12, v13
  v_max_f32 v13, 0, v13
  v_add_f32 v13, 0x3727c5ac, v13
  v_rsq_f32 v13, v13
  ds_write_b64 v43, v[12:13]
  ds_read_b128 v[136:139], v36 offset:27920
  ds_read_b128 v[140:143], v36 offset:27936
  ds_read_b128 v[144:147], v36 offset:27952
  ds_read_b128 v[148:151], v36 offset:27968
  ds_read_b128 v[152:155], v36 offset:28176
  ds_read_b128 v[156:159], v36 offset:28192
  ds_read_b128 v[160:163], v36 offset:28208
  ds_read_b128 v[164:167], v36 offset:28224
  s_waitcnt lgkmcnt(9)
  v_lshlrev_b32 v168, 16, v128
  v_and_b32 v169, 0xffff0000, v128
  v_lshlrev_b32 v170, 16, v129
  v_and_b32 v171, 0xffff0000, v129
  v_lshlrev_b32 v172, 16, v130
  v_and_b32 v173, 0xffff0000, v130
  v_lshlrev_b32 v174, 16, v131
  v_and_b32 v175, 0xffff0000, v131
  s_waitcnt lgkmcnt(4)
  v_sub_f32 v168, v168, v136
  v_sub_f32 v169, v169, v138
  v_sub_f32 v170, v170, v140
  v_sub_f32 v171, v171, v142
  v_sub_f32 v172, v172, v144
  v_sub_f32 v173, v173, v146
  v_sub_f32 v174, v174, v148
  v_sub_f32 v175, v175, v150
  v_mul_f32 v168, v168, v137
  v_mul_f32 v169, v169, v139
  v_mul_f32 v170, v170, v141
  v_mul_f32 v171, v171, v143
  v_mul_f32 v172, v172, v145
  v_mul_f32 v173, v173, v147
  v_mul_f32 v174, v174, v149
  v_mul_f32 v175, v175, v151
  v_cvt_pk_bf16_f32 v176, v168, v169
  v_cvt_pk_bf16_f32 v177, v170, v171
  v_cvt_pk_bf16_f32 v178, v172, v173
  v_cvt_pk_bf16_f32 v179, v174, v175
  buffer_store_dwordx4 v[176:179], v37, s[28:31], s42 offen offset:0 sc1
  v_lshlrev_b32 v168, 16, v132
  v_and_b32 v169, 0xffff0000, v132
  v_lshlrev_b32 v170, 16, v133
  v_and_b32 v171, 0xffff0000, v133
  v_lshlrev_b32 v172, 16, v134
  v_and_b32 v173, 0xffff0000, v134
  v_lshlrev_b32 v174, 16, v135
  v_and_b32 v175, 0xffff0000, v135
  s_waitcnt lgkmcnt(0)
  v_sub_f32 v168, v168, v152
  v_sub_f32 v169, v169, v154
  v_sub_f32 v170, v170, v156
  v_sub_f32 v171, v171, v158
  v_sub_f32 v172, v172, v160
  v_sub_f32 v173, v173, v162
  v_sub_f32 v174, v174, v164
  v_sub_f32 v175, v175, v166
  v_mul_f32 v168, v168, v153
  v_mul_f32 v169, v169, v155
  v_mul_f32 v170, v170, v157
  v_mul_f32 v171, v171, v159
  v_mul_f32 v172, v172, v161
  v_mul_f32 v173, v173, v163
  v_mul_f32 v174, v174, v165
  v_mul_f32 v175, v175, v167
  v_cvt_pk_bf16_f32 v180, v168, v169
  v_cvt_pk_bf16_f32 v181, v170, v171
  v_cvt_pk_bf16_f32 v182, v172, v173
  v_cvt_pk_bf16_f32 v183, v174, v175
  buffer_store_dwordx4 v[180:183], v37, s[28:31], s42 offen offset:1024 sc1
  s_setprio 3
  s_bitcmp1_b32 s3, 0
  s_cbranch_scc1 EX_63
  ds_write_b128 v39, v[204:207]
  s_branch EX_64
EX_63:
  ds_write_b128 v39, v[192:195] offset:0
  ds_write_b128 v39, v[196:199] offset:1024
  ds_write_b128 v39, v[200:203] offset:2048
EX_64:
  s_mov_b64 exec, 1
  ds_add_u32 v1, v2 offset:30144
  s_mov_b64 exec, -1
  s_addk_i32 m0, 1024
  s_addk_i32 s77, 8192
  buffer_load_dwordx4 v41, s[32:35], s77 offen lds
  s_addk_i32 m0, 1024
  s_addk_i32 s77, 8192
  buffer_load_dwordx4 v41, s[32:35], s77 offen lds
  s_addk_i32 m0, 1024
  s_addk_i32 s77, 8192
  buffer_load_dwordx4 v41, s[32:35], s77 offen lds
  s_addk_i32 m0, 1024
  s_addk_i32 s77, 8192
  buffer_load_dwordx4 v41, s[32:35], s77 offen lds
  s_addk_i32 m0, 1024
  s_addk_i32 s77, 8192
  buffer_load_dwordx4 v41, s[32:35], s77 offen lds
  s_addk_i32 m0, 1024
  s_addk_i32 s77, 8192
  buffer_load_dwordx4 v41, s[32:35], s77 offen lds
  s_addk_i32 m0, 1024
  s_addk_i32 s77, 8192
  buffer_load_dwordx4 v41, s[32:35], s77 offen lds
  s_addk_i32 m0, 1024
  s_addk_i32 s77, 8192
  buffer_load_dwordx4 v41, s[32:35], s77 offen lds
  ds_read_b32 v3, v1 offset:30144
  s_mul_i32 s70, s76, 133120
  s_lshl_b32 s79, s75, 6
  s_add_u32 s70, s70, s79
  v_lshrrev_b32 v12, 3, v0
  v_mul_u32_u24 v62, 8320, v12
  v_add_u32 v62, s70, v62
  v_bfe_u32 v13, v0, 2, 1
  v_lshl_add_u32 v62, v13, 10, v62
  v_and_b32 v14, 3, v0
  v_lshl_add_u32 v62, v14, 4, v62
  s_mul_i32 s70, s75, 4608
  s_add_u32 s70, s70, 147456
  v_and_b32 v15, 31, v0
  v_lshl_add_u32 v38, v15, 4, s70
  s_lshl_b32 s71, s76, 8
  s_sub_u32 s70, s70, s71
  s_add_u32 s70, s70, 480
  v_and_b32 v16, 15, v0
  v_lshl_add_u32 v6, v16, 5, s70
  v_lshrrev_b32 v17, 4, v0
  v_lshl_add_u32 v6, v17, 4, v6
  v_and_b32 v18, 1, v0
  v_mul_u32_u24 v8, 4164, v18
  v_bfe_u32 v19, v0, 1, 3
  v_lshl_add_u32 v8, v19, 2, v8
  s_sub_u32 s70, s60, s71
  s_add_u32 s70, s70, 7648
  v_sub_u32 v8, s70, v8
  v_lshl_add_u32 v8, v17, 4, v8
  v_subrev_u32 v9, 1024, v8
  v_subrev_u32 v10, 2048, v8
  v_subrev_u32 v11, 3072, v8
  s_lshl_b32 s70, s75, 4
  v_and_b32 v5, s70, v0
  v_lshl_add_u32 v5, v5, 27, v4
  s_lshl_b32 s70, s3, 13
  s_add_u32 s70, s70, 98304
  v_add_u32 v63, s70, v4
  s_waitcnt lgkmcnt(0)
  v_readfirstlane_b32 s78, v3
  s_nop 0
  s_cmp_ge_u32 s78, 4
  s_cbranch_scc1 OK_65
  s_mov_b32 s79, 1000000
SP_66:
  ds_read_b32 v3, v1 offset:30144
  s_waitcnt lgkmcnt(0)
  v_readfirstlane_b32 s78, v3
  s_nop 0
  s_cmp_ge_u32 s78, 4
  s_cbranch_scc1 SPE_67
  s_sub_u32 s79, s79, 1
  s_cbranch_scc0 SP_66
SPE_67:
OK_65:
  ds_read_b128 v[96:99], v40 offset:0
  ds_read_b128 v[100:103], v40 offset:1024
  ds_read_b128 v[104:107], v40 offset:2048
  s_mov_b64 exec, 1
  ds_add_u32 v1, v2 offset:30164
  s_mov_b64 exec, -1
  s_waitcnt vmcnt(8)
  s_mov_b64 exec, 1
  ds_add_rtn_u32 v3, v1, v2 offset:30108
  s_waitcnt lgkmcnt(0)
  v_readfirstlane_b32 s78, v3
  s_nop 0
  s_cmp_eq_u32 s78, 3
  s_cbranch_scc0 PB_68
  v_mov_b32 v3, s68
  buffer_store_dword v3, off, s[28:31], s26 offset:512 sc1
PB_68:
  s_mov_b64 exec, -1
  s_waitcnt vmcnt(0)
  s_mov_b64 exec, 1
  ds_add_u32 v1, v2 offset:30064
  s_mov_b64 exec, -1
  buffer_store_dwordx4 v[112:115], v4, s[28:31], s37 offen sc1
  buffer_store_dwordx4 v[116:119], v4, s[28:31], s38 offen sc1
  buffer_store_dwordx4 v[120:123], v4, s[28:31], s39 offen sc1
  s_cmp_lg_u32 s3, 3
  s_cbranch_scc1 SCX_71
  s_add_u32 s92, s90, s27
  s_addc_u32 s93, s91, 0
  s_mov_b32 s79, 200000
SC_69:
  s_load_dwordx8 s[8:15], s[92:93], 0 glc
  s_load_dwordx8 s[16:23], s[92:93], 128 glc
  s_load_dwordx8 s[52:59], s[92:93], 256 glc
  s_load_dwordx8 s[60:67], s[92:93], 384 glc
  s_waitcnt lgkmcnt(0)
  s_xor_b64 s[8:9], s[8:9], s[68:69]
  s_xor_b64 s[10:11], s[10:11], s[68:69]
  s_xor_b64 s[12:13], s[12:13], s[68:69]
  s_xor_b64 s[14:15], s[14:15], s[68:69]
  s_xor_b64 s[16:17], s[16:17], s[68:69]
  s_xor_b64 s[18:19], s[18:19], s[68:69]
  s_xor_b64 s[20:21], s[20:21], s[68:69]
  s_xor_b64 s[22:23], s[22:23], s[68:69]
  s_xor_b64 s[52:53], s[52:53], s[68:69]
  s_xor_b64 s[54:55], s[54:55], s[68:69]
  s_xor_b64 s[56:57], s[56:57], s[68:69]
  s_xor_b64 s[58:59], s[58:59], s[68:69]
  s_xor_b64 s[60:61], s[60:61], s[68:69]
  s_xor_b64 s[62:63], s[62:63], s[68:69]
  s_xor_b64 s[64:65], s[64:65], s[68:69]
  s_xor_b64 s[66:67], s[66:67], s[68:69]
  s_or_b64 s[8:9], s[8:9], s[10:11]
  s_or_b64 s[8:9], s[8:9], s[12:13]
  s_or_b64 s[8:9], s[8:9], s[14:15]
  s_or_b64 s[8:9], s[8:9], s[16:17]
  s_or_b64 s[8:9], s[8:9], s[18:19]
  s_or_b64 s[8:9], s[8:9], s[20:21]
  s_or_b64 s[8:9], s[8:9], s[22:23]
  s_or_b64 s[8:9], s[8:9], s[52:53]
  s_or_b64 s[8:9], s[8:9], s[54:55]
  s_or_b64 s[8:9], s[8:9], s[56:57]
  s_or_b64 s[8:9], s[8:9], s[58:59]
  s_or_b64 s[8:9], s[8:9], s[60:61]
  s_or_b64 s[8:9], s[8:9], s[62:63]
  s_or_b64 s[8:9], s[8:9], s[64:65]
  s_or_b64 s[8:9], s[8:9], s[66:67]
  s_cbranch_scc0 SCE_70
  s_sleep 2
  s_sub_u32 s79, s79, 1
  s_cbranch_scc0 SC_69
SCE_70:
  s_mov_b64 exec, 1
  ds_add_u32 v1, v2 offset:30148
  s_mov_b64 exec, -1
SCX_71:
  s_mov_b32 s79, 1000000
SP_72:
  ds_read_b32 v3, v1 offset:30164
  s_waitcnt lgkmcnt(0)
  v_readfirstlane_b32 s78, v3
  s_nop 0
  s_cmp_ge_u32 s78, 4
  s_cbranch_scc1 SPE_73
  s_sub_u32 s79, s79, 1
  s_cbranch_scc0 SP_72
SPE_73:
  s_bitcmp1_b32 s3, 0
  s_cbranch_scc1 EX_74
  v_mov_b32 v12, 0
  v_add_f32 v192, v192, v96
  v_add_f32 v193, v193, v97
  v_add_f32 v194, v194, v98
  v_add_f32 v195, v195, v99
  v_add_f32 v196, v196, v100
  v_add_f32 v197, v197, v101
  v_add_f32 v198, v198, v102
  v_add_f32 v199, v199, v103
  v_add_f32 v200, v200, v104
  v_add_f32 v201, v201, v105
  v_add_f32 v202, v202, v106
  v_add_f32 v203, v203, v107
  s_mov_b64 exec, 1
  v_add_f32 v192, s67, v192
  v_cvt_pk_bf16_f32 v12, v192, v12
  s_mov_b64 exec, 0xffff
  ds_write_b32 v29, v12 offset:4096
  s_mov_b64 exec, -1
  v_cvt_pk_bf16_f32 v208, v199, v198
  v_cvt_pk_bf16_f32 v209, v197, v196
  v_cvt_pk_bf16_f32 v210, v195, v194
  v_cvt_pk_bf16_f32 v211, v193, v192
  v_cvt_pk_bf16_f32 v212, v200, v199
  v_cvt_pk_bf16_f32 v213, v198, v197
  v_cvt_pk_bf16_f32 v214, v196, v195
  v_cvt_pk_bf16_f32 v215, v194, v193
  ds_write_b128 v28, v[208:211] offset:3072
  ds_write_b128 v28, v[212:215] offset:7232
  v_cvt_pk_bf16_f32 v216, v203, v203
  v_cvt_pk_bf16_f32 v217, v202, v202
  v_cvt_pk_bf16_f32 v218, v202, v201
  v_cvt_pk_bf16_f32 v219, v201, v201
  v_cvt_pk_bf16_f32 v220, v203, v203
  v_cvt_pk_bf16_f32 v221, v203, v202
  v_cvt_pk_bf16_f32 v222, v202, v202
  v_cvt_pk_bf16_f32 v223, v201, v201
  ds_write_b128 v28, v[216:219] offset:2048
  ds_write_b128 v28, v[220:223] offset:6208
  s_branch EX_75
EX_74:
  s_mov_b32 vcc_lo, 0xaaaaaaaa
  s_mov_b32 vcc_hi, vcc_lo
  v_add_f32 v204, v204, v96
  v_add_f32 v205, v205, v97
  v_add_f32 v206, v206, v98
  v_add_f32 v207, v207, v99
  v_cndmask_b32 v12, v204, v205, vcc
  v_cvt_pk_bf16_f32 v208, v205, v205
  v_cvt_pk_bf16_f32 v209, v205, v12
  v_cvt_pk_bf16_f32 v210, v204, v204
  v_cvt_pk_bf16_f32 v211, v204, v204
  v_cvt_pk_bf16_f32 v212, v205, v205
  v_cvt_pk_bf16_f32 v213, v205, v205
  v_cvt_pk_bf16_f32 v214, v12, v204
  v_cvt_pk_bf16_f32 v215, v204, v204
  ds_write_b128 v28, v[208:211] offset:1024
  ds_write_b128 v28, v[212:215] offset:5184
  v_cndmask_b32 v12, v206, v207, vcc
  v_cvt_pk_bf16_f32 v216, v207, v207
  v_cvt_pk_bf16_f32 v217, v207, v12
  v_cvt_pk_bf16_f32 v218, v206, v206
  v_cvt_pk_bf16_f32 v219, v206, v206
  v_cvt_pk_bf16_f32 v220, v207, v207
  v_cvt_pk_bf16_f32 v221, v207, v207
  v_cvt_pk_bf16_f32 v222, v12, v206
  v_cvt_pk_bf16_f32 v223, v206, v206
  ds_write_b128 v28, v[216:219] offset:0
  ds_write_b128 v28, v[220:223] offset:4160
EX_75:
  s_lshl_b32 s70, s73, 12
  s_add_u32 s41, s41, s70
  s_mov_b64 exec, 1
  ds_add_u32 v1, v2 offset:30168
  s_mov_b64 exec, -1
  v_mov_b32 v24, v38
  s_lshl_b32 s70, s3, 8
  s_add_u32 s70, s70, 28992
  v_lshl_add_u32 v7, v0, 2, s70
  v_mov_b32 v28, 0
  v_mov_b32 v29, 0
  v_mov_b32 v30, 0
  v_mov_b32 v31, 0
  v_mov_b32 v32, 0
  v_mov_b32 v33, 0
  v_mov_b32 v34, 0
  v_mov_b32 v35, 0
  v_mov_b32 v36, 0
  v_mov_b32 v37, 0
  v_mov_b32 v38, 0
  v_mov_b32 v39, 0
  v_mov_b32 v40, 0
  v_mov_b32 v41, 0
  v_mov_b32 v42, 0
  v_mov_b32 v43, 0
  v_mov_b32 v44, 0
  v_mov_b32 v45, 0
  v_mov_b32 v46, 0
  v_mov_b32 v47, 0
  v_mov_b32 v48, 0
  v_mov_b32 v49, 0
  v_mov_b32 v50, 0
  v_mov_b32 v51, 0
  v_mov_b32 v52, 0
  v_mov_b32 v53, 0
  v_mov_b32 v54, 0
  v_mov_b32 v55, 0
  v_mov_b32 v56, 0
  v_mov_b32 v57, 0
  v_mov_b32 v58, 0
  v_mov_b32 v59, 0
  s_mov_b32 m0, s72
  s_mov_b32 vcc_lo, 0xaaaa5555
  s_mov_b32 vcc_hi, vcc_lo
  v_mov_b32 v12, s84
  v_cndmask_b32 v15, 0, v12, vcc
  v_cndmask_b32 v14, 0, v12, vcc
  v_cndmask_b32 v13, 0, v12, vcc
  v_cndmask_b32 v12, 0, v12, vcc
  s_mov_b32 s79, 1000000
SP_76:
  ds_read_b32 v3, v1 offset:30148
  s_waitcnt lgkmcnt(0)
  v_readfirstlane_b32 s78, v3
  s_nop 0
  s_cmp_ge_u32 s78, 1
  s_cbranch_scc1 SPE_77
  s_sub_u32 s79, s79, 1
  s_cbranch_scc0 SP_76
SPE_77:
  buffer_load_dwordx4 v[64:67], v5, s[28:31], s41 offen offset:0 sc1
  buffer_load_dwordx4 v[68:71], v5, s[28:31], s41 offen offset:1024 sc1
  buffer_load_dwordx4 v[72:75], v5, s[28:31], s41 offen offset:2048 sc1
  buffer_load_dwordx4 v[76:79], v5, s[28:31], s41 offen offset:3072 sc1
  s_xor_b32 s41, s41, 4096
  buffer_load_dwordx4 v[80:83], v5, s[28:31], s41 offen offset:0 sc1
  buffer_load_dwordx4 v[84:87], v5, s[28:31], s41 offen offset:1024 sc1
  buffer_load_dwordx4 v[88:91], v5, s[28:31], s41 offen offset:2048 sc1
  buffer_load_dwordx4 v[92:95], v5, s[28:31], s41 offen offset:3072 sc1
  s_waitcnt vmcnt(8)
  s_mov_b64 exec, 1
  ds_add_rtn_u32 v3, v1, v2 offset:30112
  s_waitcnt lgkmcnt(0)
  v_readfirstlane_b32 s78, v3
  s_nop 0
  s_cmp_eq_u32 s78, 3
  s_cbranch_scc0 PB_78
  v_mov_b32 v3, s68
  buffer_store_dword v3, off, s[28:31], s26 offset:1536 sc1
PB_78:
  s_mov_b64 exec, -1
  s_waitcnt vmcnt(7)
  v_mfma_f32_16x16x32_bf16 v[16:19], v[12:15], v[64:67], 0
  s_xor_b32 s41, s41, 4096
  s_addk_i32 s41, 8192
  buffer_load_dwordx4 v[96:99], v5, s[28:31], s41 offen offset:0 sc1
  s_waitcnt vmcnt(7)
  v_mfma_f32_16x16x32_bf16 v[16:19], v[12:15], v[68:71], v[16:19]
  buffer_load_dwordx4 v[100:103], v5, s[28:31], s41 offen offset:1024 sc1
  s_waitcnt vmcnt(7)
  v_mfma_f32_16x16x32_bf16 v[16:19], v[12:15], v[72:75], v[16:19]
  buffer_load_dwordx4 v[104:107], v5, s[28:31], s41 offen offset:2048 sc1
  s_waitcnt vmcnt(7)
  v_mfma_f32_16x16x32_bf16 v[16:19], v[12:15], v[76:79], v[16:19]
  buffer_load_dwordx4 v[108:111], v5, s[28:31], s41 offen offset:3072 sc1
  s_cmp_lg_u32 s3, 1
  s_cbranch_scc1 SCX_81
  s_add_u32 s92, s90, s27
  s_addc_u32 s93, s91, 0
  s_mov_b32 s79, 200000
SC_79:
  s_load_dwordx8 s[8:15], s[92:93], 512 glc
  s_load_dwordx8 s[16:23], s[92:93], 640 glc
  s_load_dwordx8 s[52:59], s[92:93], 768 glc
  s_load_dwordx8 s[60:67], s[92:93], 896 glc
  s_waitcnt lgkmcnt(0)
  s_xor_b64 s[8:9], s[8:9], s[68:69]
  s_xor_b64 s[10:11], s[10:11], s[68:69]
  s_xor_b64 s[12:13], s[12:13], s[68:69]
  s_xor_b64 s[14:15], s[14:15], s[68:69]
  s_xor_b64 s[16:17], s[16:17], s[68:69]
  s_xor_b64 s[18:19], s[18:19], s[68:69]
  s_xor_b64 s[20:21], s[20:21], s[68:69]
  s_xor_b64 s[22:23], s[22:23], s[68:69]
  s_xor_b64 s[52:53], s[52:53], s[68:69]
  s_xor_b64 s[54:55], s[54:55], s[68:69]
  s_xor_b64 s[56:57], s[56:57], s[68:69]
  s_xor_b64 s[58:59], s[58:59], s[68:69]
  s_xor_b64 s[60:61], s[60:61], s[68:69]
  s_xor_b64 s[62:63], s[62:63], s[68:69]
  s_xor_b64 s[64:65], s[64:65], s[68:69]
  s_xor_b64 s[66:67], s[66:67], s[68:69]
  s_or_b64 s[8:9], s[8:9], s[10:11]
  s_or_b64 s[8:9], s[8:9], s[12:13]
  s_or_b64 s[8:9], s[8:9], s[14:15]
  s_or_b64 s[8:9], s[8:9], s[16:17]
  s_or_b64 s[8:9], s[8:9], s[18:19]
  s_or_b64 s[8:9], s[8:9], s[20:21]
  s_or_b64 s[8:9], s[8:9], s[22:23]
  s_or_b64 s[8:9], s[8:9], s[52:53]
  s_or_b64 s[8:9], s[8:9], s[54:55]
  s_or_b64 s[8:9], s[8:9], s[56:57]
  s_or_b64 s[8:9], s[8:9], s[58:59]
  s_or_b64 s[8:9], s[8:9], s[60:61]
  s_or_b64 s[8:9], s[8:9], s[62:63]
  s_or_b64 s[8:9], s[8:9], s[64:65]
  s_or_b64 s[8:9], s[8:9], s[66:67]
  s_cbranch_scc0 SCE_80
  s_sleep 2
  s_sub_u32 s79, s79, 1
  s_cbranch_scc0 SC_79
SCE_80:
  s_mov_b64 exec, 1
  ds_add_u32 v1, v2 offset:30152
  s_mov_b64 exec, -1
SCX_81:
  s_waitcnt vmcnt(7)
  v_mfma_f32_16x16x32_bf16 v[16:19], v[12:15], v[80:83], v[16:19]
  s_xor_b32 s41, s41, 4096
  buffer_load_dwordx4 v[112:115], v5, s[28:31], s41 offen offset:0 sc1
  s_waitcnt vmcnt(7)
  v_mfma_f32_16x16x32_bf16 v[16:19], v[12:15], v[84:87], v[16:19]
  buffer_load_dwordx4 v[116:119], v5, s[28:31], s41 offen offset:1024 sc1
  s_waitcnt vmcnt(7)
  v_mfma_f32_16x16x32_bf16 v[16:19], v[12:15], v[88:91], v[16:19]
  buffer_load_dwordx4 v[120:123], v5, s[28:31], s41 offen offset:2048 sc1
  s_waitcnt vmcnt(7)
  v_mfma_f32_16x16x32_bf16 v[16:19], v[12:15], v[92:95], v[16:19]
  buffer_load_dwordx4 v[124:127], v5, s[28:31], s41 offen offset:3072 sc1
  s_waitcnt vmcnt(7)
  v_mfma_f32_16x16x32_bf16 v[16:19], v[12:15], v[96:99], v[16:19]
  s_xor_b32 s41, s41, 4096
  s_addk_i32 s41, 8192
  buffer_load_dwordx4 v[128:131], v4, s[28:31], s41 offen offset:0 sc1
  s_waitcnt vmcnt(7)
  v_mfma_f32_16x16x32_bf16 v[16:19], v[12:15], v[100:103], v[16:19]
  buffer_load_dwordx4 v[132:135], v4, s[28:31], s41 offen offset:1024 sc1
  s_waitcnt vmcnt(7)
  v_mfma_f32_16x16x32_bf16 v[16:19], v[12:15], v[104:107], v[16:19]
  buffer_load_dwordx4 v[136:139], v4, s[28:31], s41 offen offset:2048 sc1
  s_waitcnt vmcnt(7)
  v_mfma_f32_16x16x32_bf16 v[16:19], v[12:15], v[108:111], v[16:19]
  buffer_load_dwordx4 v[140:143], v4, s[28:31], s41 offen offset:3072 sc1
  s_mov_b32 s79, 1000000
SP_82:
  ds_read_b32 v3, v1 offset:30068
  s_waitcnt lgkmcnt(0)
  v_readfirstlane_b32 s78, v3
  s_nop 0
  s_cmp_ge_u32 s78, 4
  s_cbranch_scc1 SPE_83
  s_sub_u32 s79, s79, 1
  s_cbranch_scc0 SP_82
SPE_83:
  ds_write_b128 v24, v[28:31]
  s_mov_b32 s79, 1000000
SP_84:
  ds_read_b32 v3, v1 offset:30152
  s_waitcnt lgkmcnt(0)
  v_readfirstlane_b32 s78, v3
  s_nop 0
  s_cmp_ge_u32 s78, 1
  s_cbranch_scc1 SPE_85
  s_sub_u32 s79, s79, 1
  s_cbranch_scc0 SP_84
SPE_85:
  buffer_load_dwordx4 v62, s[28:31], s43 offen sc1 lds
  s_addk_i32 m0, 1024
  s_add_u32 s43, s43, 66560
  buffer_load_dwordx4 v62, s[28:31], s43 offen sc1 lds
  s_mov_b32 s79, 1000000
SP_86:
  ds_read_b32 v3, v1 offset:30168
  s_waitcnt lgkmcnt(0)
  v_readfirstlane_b32 s78, v3
  s_nop 0
  s_cmp_ge_u32 s78, 4
  s_cbranch_scc1 SPE_87
  s_sub_u32 s79, s79, 1
  s_cbranch_scc0 SP_86
SPE_87:
  ds_read2_b32 v[220:221], v11 offset0:16 offset1:17
  ds_read2_b32 v[222:223], v11 offset0:18 offset1:19
  ds_read2_b32 v[216:217], v11 offset0:144 offset1:145
  ds_read2_b32 v[218:219], v11 offset0:146 offset1:147
  ds_read2_b32 v[212:213], v10 offset0:16 offset1:17
  ds_read2_b32 v[214:215], v10 offset0:18 offset1:19
  ds_read2_b32 v[208:209], v10 offset0:144 offset1:145
  ds_read2_b32 v[210:211], v10 offset0:146 offset1:147
  s_waitcnt vmcnt(9)
  v_mfma_f32_16x16x32_bf16 v[16:19], v[12:15], v[112:115], v[16:19]
  s_waitcnt vmcnt(8)
  v_mfma_f32_16x16x32_bf16 v[16:19], v[12:15], v[116:119], v[16:19]
  s_waitcnt vmcnt(7)
  v_mfma_f32_16x16x32_bf16 v[16:19], v[12:15], v[120:123], v[16:19]
  s_waitcnt vmcnt(6)
  v_mfma_f32_16x16x32_bf16 v[16:19], v[12:15], v[124:127], v[16:19]
  s_waitcnt vmcnt(5)
  v_mfma_f32_16x16x32_bf16 v[20:23], v[12:15], v[128:131], 0
  s_waitcnt vmcnt(4)
  v_mfma_f32_16x16x32_bf16 v[20:23], v[12:15], v[132:135], v[20:23]
  s_waitcnt vmcnt(3)
  v_mfma_f32_16x16x32_bf16 v[20:23], v[12:15], v[136:139], v[20:23]
  s_waitcnt vmcnt(2)
  v_mfma_f32_16x16x32_bf16 v[20:23], v[12:15], v[140:143], v[20:23]
  s_mov_b64 exec, 0xffff
  ds_write2_b32 v7, v16, v17 offset0:0 offset1:16
  s_mov_b64 exec, -1
  s_nop 4
  v_mov_b32 v60, v20
  v_mov_b32 v61, v21
  ds_read2_b32 v[24:25], v9 offset0:16 offset1:17
  ds_read2_b32 v[26:27], v9 offset0:18 offset1:19
  ds_read2_b32 v[20:21], v9 offset0:144 offset1:145
  ds_read2_b32 v[22:23], v9 offset0:146 offset1:147
  ds_read2_b32 v[16:17], v8 offset0:16 offset1:17
  ds_read2_b32 v[18:19], v8 offset0:18 offset1:19
  ds_read2_b32 v[12:13], v8 offset0:144 offset1:145
  ds_read2_b32 v[14:15], v8 offset0:146 offset1:147
  s_waitcnt vmcnt(0)
  s_mov_b64 exec, 1
  ds_add_u32 v1, v2 offset:30096
  s_mov_b64 exec, -1
  s_mov_b32 s79, 1000000
SP_88:
  ds_read_b32 v3, v1 offset:30096
  s_waitcnt lgkmcnt(0)
  v_readfirstlane_b32 s78, v3
  s_nop 0
  s_cmp_ge_u32 s78, 4
  s_cbranch_scc1 SPE_89
  s_sub_u32 s79, s79, 1
  s_cbranch_scc0 SP_88
SPE_89:
  s_setprio 0
  ds_read_b128 v[224:227], v6 offset:0
  ds_read_b128 v[228:231], v6 offset:512
  ds_read_b128 v[232:235], v6 offset:1024
  ds_read_b128 v[236:239], v6 offset:1536
  ds_read_b128 v[240:243], v6 offset:2048
  ds_read_b128 v[244:247], v6 offset:2560
  ds_read_b128 v[248:251], v6 offset:3072
  ds_read_b128 v[252:255], v6 offset:3584
  v_subrev_u32 v6, 64, v6
  s_waitcnt lgkmcnt(4)
  s_xor_b32 s41, s41, 4096
  buffer_load_dwordx4 v[144:147], v4, s[28:31], s41 offen offset:0 sc1
  buffer_load_dwordx4 v[148:151], v4, s[28:31], s41 offen offset:1024 sc1
  buffer_load_dwordx4 v[152:155], v4, s[28:31], s41 offen offset:2048 sc1
  buffer_load_dwordx4 v[156:159], v4, s[28:31], s41 offen offset:3072 sc1
  s_call_b64 s[88:89], L_conv
  s_xor_b32 s41, s41, 4096
  s_addk_i32 s41, 8192
  buffer_load_dwordx4 v[160:163], v4, s[28:31], s41 offen offset:0 sc1
  buffer_load_dwordx4 v[164:167], v4, s[28:31], s41 offen offset:1024 sc1
  buffer_load_dwordx4 v[168:171], v4, s[28:31], s41 offen offset:2048 sc1
  buffer_load_dwordx4 v[172:175], v4, s[28:31], s41 offen offset:3072 sc1
  s_call_b64 s[88:89], L_conv
  s_xor_b32 s41, s41, 4096
  buffer_load_dwordx4 v[176:179], v4, s[28:31], s41 offen offset:0 sc1
  buffer_load_dwordx4 v[180:183], v4, s[28:31], s41 offen offset:1024 sc1
  buffer_load_dwordx4 v[184:187], v4, s[28:31], s41 offen offset:2048 sc1
  buffer_load_dwordx4 v[188:191], v4, s[28:31], s41 offen offset:3072 sc1
  v_lshrrev_b32 v62, 3, v0
  v_mul_u32_u24 v62, 96, v62
  v_lshl_add_u32 v62, v0, 2, v62
  s_mov_b32 exec_hi, 0
  buffer_load_dword v5, v62, s[28:31], s27 offen offset:1536 sc1
  s_mov_b32 exec_hi, -1
  s_call_b64 s[88:89], L_conv
  s_xor_b32 s41, s41, 4096
  s_addk_i32 s41, 8192
  buffer_load_dwordx4 v[192:195], v4, s[28:31], s41 offen offset:0 sc1
  buffer_load_dwordx4 v[196:199], v4, s[28:31], s41 offen offset:1024 sc1
  buffer_load_dwordx4 v[200:203], v4, s[28:31], s41 offen offset:2048 sc1
  buffer_load_dwordx4 v[204:207], v4, s[28:31], s41 offen offset:3072 sc1
  s_call_b64 s[88:89], L_conv
  s_nop 1
  ds_write_b128 v63, v[28:31] offset:0
  ds_write_b128 v63, v[32:35] offset:1024
  ds_write_b128 v63, v[36:39] offset:2048
  ds_write_b128 v63, v[40:43] offset:3072
  ds_write_b128 v63, v[44:47] offset:4096
  ds_write_b128 v63, v[48:51] offset:5120
  ds_write_b128 v63, v[52:55] offset:6144
  ds_write_b128 v63, v[56:59] offset:7168
  s_waitcnt vmcnt(4)
  s_mov_b32 s79, 200000
  s_mov_b32 exec_hi, 0
CP_90:
  v_cmp_ne_u32 vcc, s68, v5
  s_nop 4
  s_cbranch_vccz CPE_91
  s_sleep 2
  buffer_load_dword v5, v62, s[28:31], s27 offen offset:1536 sc1
  s_waitcnt vmcnt(0)
  s_sub_u32 s79, s79, 1
  s_cbranch_scc0 CP_90
CPE_91:
  s_mov_b32 exec_hi, -1
  s_mov_b64 exec, 1
  ds_add_u32 v1, v2 offset:30136
  s_mov_b64 exec, -1
  ds_read_b32 v5, v1 offset:30128
  s_mul_i32 s70, s76, 36864
  s_add_u32 s70, s70, 32768
  v_add_u32 v8, s70, v4
  v_xor_b32 v9, 0x1000, v8
  s_lshl_b32 s70, s3, 13
  s_add_u32 s70, s70, 131072
  v_add_u32 v10, s70, v4
  v_and_b32 v11, 31, v0
  v_lshlrev_b32 v11, 3, v11
  v_add_u32 v6, 32768, v4
  s_waitcnt lgkmcnt(0)
  s_xor_b32 s41, s41, 4096
  buffer_load_dwordx4 v[208:211], v4, s[28:31], s41 offen offset:0 sc1
  buffer_load_dwordx4 v[212:215], v4, s[28:31], s41 offen offset:1024 sc1
  buffer_load_dwordx4 v[216:219], v4, s[28:31], s41 offen offset:2048 sc1
  buffer_load_dwordx4 v[220:223], v4, s[28:31], s41 offen offset:3072 sc1
  v_readfirstlane_b32 s24, v5
  s_mov_b32 vcc_lo, 0xaaaa5555
  s_mov_b32 vcc_hi, vcc_lo
  v_mov_b32 v12, s84
  v_cndmask_b32 v15, 0, v12, vcc
  v_cndmask_b32 v14, 0, v12, vcc
  v_cndmask_b32 v13, 0, v12, vcc
  v_cndmask_b32 v12, 0, v12, vcc
  v_lshrrev_b32 v5, 5, v0
  s_lshl_b32 s70, s3, 8
  s_add_u32 s70, s70, 29120
  v_lshl_add_u32 v5, v5, 4, s70
  v_mov_b32 v20, v60
  v_mov_b32 v21, v61
  s_nop 1
  v_mfma_f32_16x16x32_bf16 v[20:23], v[12:15], v[144:147], v[20:23]
  v_mfma_f32_16x16x32_bf16 v[20:23], v[12:15], v[148:151], v[20:23]
  v_mfma_f32_16x16x32_bf16 v[20:23], v[12:15], v[152:155], v[20:23]
  v_mfma_f32_16x16x32_bf16 v[20:23], v[12:15], v[156:159], v[20:23]
  v_mfma_f32_16x16x32_bf16 v[20:23], v[12:15], v[160:163], v[20:23]
  v_mfma_f32_16x16x32_bf16 v[20:23], v[12:15], v[164:167], v[20:23]
  v_mfma_f32_16x16x32_bf16 v[20:23], v[12:15], v[168:171], v[20:23]
  v_mfma_f32_16x16x32_bf16 v[20:23], v[12:15], v[172:175], v[20:23]
  v_mfma_f32_16x16x32_bf16 v[20:23], v[12:15], v[176:179], v[20:23]
  v_mfma_f32_16x16x32_bf16 v[20:23], v[12:15], v[180:183], v[20:23]
  v_mfma_f32_16x16x32_bf16 v[20:23], v[12:15], v[184:187], v[20:23]
  v_mfma_f32_16x16x32_bf16 v[20:23], v[12:15], v[188:191], v[20:23]
  s_waitcnt vmcnt(7)
  v_mfma_f32_16x16x32_bf16 v[20:23], v[12:15], v[192:195], v[20:23]
  s_waitcnt vmcnt(6)
  v_mfma_f32_16x16x32_bf16 v[20:23], v[12:15], v[196:199], v[20:23]
  s_waitcnt vmcnt(5)
  v_mfma_f32_16x16x32_bf16 v[20:23], v[12:15], v[200:203], v[20:23]
  s_waitcnt vmcnt(4)
  v_mfma_f32_16x16x32_bf16 v[20:23], v[12:15], v[204:207], v[20:23]
  s_mov_b32 s79, 1000000
SP_92:
  ds_read_b32 v3, v1 offset:30088
  s_waitcnt lgkmcnt(0)
  v_readfirstlane_b32 s78, v3
  s_nop 0
  s_cmp_ge_u32 s78, 4
  s_cbranch_scc1 SPE_93
  s_sub_u32 s79, s79, 1
  s_cbranch_scc0 SP_92
SPE_93:
  s_setprio 2
  ds_read_b128 v[16:19], v8 offset:0
  ds_read_b128 v[24:27], v9 offset:0
  ds_read_b128 v[60:63], v8 offset:1024
  s_waitcnt lgkmcnt(2)
  v_mfma_f32_32x32x16_bf16 v[28:43], v[64:67], v[16:19], 0
  ds_read_b128 v[16:19], v9 offset:1024
  ds_read_b32 v3, v1 offset:30024
  s_waitcnt lgkmcnt(3)
  v_mfma_f32_32x32x16_bf16 v[44:59], v[64:67], v[24:27], 0
  ds_read_b128 v[24:27], v8 offset:16384
  ds_read_b128 v[64:67], v9 offset:16384
  s_waitcnt lgkmcnt(4)
  v_mfma_f32_32x32x16_bf16 v[28:43], v[68:71], v[60:63], v[28:43]
  s_xor_b32 s41, s41, 4096
  s_addk_i32 s41, 8192
  buffer_load_dwordx4 v[224:227], v4, s[28:31], s41 offen offset:0 sc1
  ds_read_b128 v[60:63], v8 offset:17408
  s_waitcnt lgkmcnt(4)
  v_mfma_f32_32x32x16_bf16 v[44:59], v[68:71], v[16:19], v[44:59]
  ds_read_b128 v[16:19], v9 offset:17408
  s_waitcnt lgkmcnt(4)
  v_readfirstlane_b32 s78, v3
  s_nop 0
  s_cmp_ge_u32 s78, 4
  s_cbranch_scc1 OK_94
  s_mov_b32 s79, 1000000
SP_95:
  ds_read_b32 v3, v1 offset:30024
  s_waitcnt lgkmcnt(0)
  v_readfirstlane_b32 s78, v3
  s_nop 0
  s_cmp_ge_u32 s78, 4
  s_cbranch_scc1 SPE_96
  s_sub_u32 s79, s79, 1
  s_cbranch_scc0 SP_95
SPE_96:
OK_94:
  ds_read_b32 v3, v1 offset:30092
  ds_read_b128 v[68:71], v8 offset:2048
  s_waitcnt lgkmcnt(5)
  v_mfma_f32_32x32x16_bf16 v[28:43], v[96:99], v[24:27], v[28:43]
  ds_read_b128 v[24:27], v9 offset:2048
  s_waitcnt lgkmcnt(5)
  v_mfma_f32_32x32x16_bf16 v[44:59], v[96:99], v[64:67], v[44:59]
  buffer_load_dwordx4 v[228:231], v4, s[28:31], s41 offen offset:1024 sc1
  ds_read_b128 v[64:67], v8 offset:3072
  ds_read_b128 v[96:99], v9 offset:3072
  s_waitcnt lgkmcnt(6)
  v_mfma_f32_32x32x16_bf16 v[28:43], v[100:103], v[60:63], v[28:43]
  ds_read_b128 v[60:63], v8 offset:18432
  s_waitcnt lgkmcnt(6)
  v_mfma_f32_32x32x16_bf16 v[44:59], v[100:103], v[16:19], v[44:59]
  ds_read_b128 v[16:19], v9 offset:18432
  ds_read_b128 v[100:103], v8 offset:19456
  s_waitcnt lgkmcnt(5)
  v_mfma_f32_32x32x16_bf16 v[28:43], v[72:75], v[68:71], v[28:43]
  buffer_load_dwordx4 v[232:235], v4, s[28:31], s41 offen offset:2048 sc1
  ds_read_b128 v[68:71], v9 offset:19456
  v_mfma_f32_32x32x16_bf16 v[44:59], v[72:75], v[24:27], v[44:59]
  v_readfirstlane_b32 s78, v3
  s_nop 0
  s_cmp_ge_u32 s78, 4
  s_cbranch_scc1 OK_97
  s_mov_b32 s79, 1000000
SP_98:
  ds_read_b32 v3, v1 offset:30092
  s_waitcnt lgkmcnt(0)
  v_readfirstlane_b32 s78, v3
  s_nop 0
  s_cmp_ge_u32 s78, 4
  s_cbranch_scc1 SPE_99
  s_sub_u32 s79, s79, 1
  s_cbranch_scc0 SP_98
SPE_99:
OK_97:
  ds_read_b128 v[24:27], v8 offset:8192
  s_waitcnt lgkmcnt(5)
  v_mfma_f32_32x32x16_bf16 v[28:43], v[76:79], v[64:67], v[28:43]
  ds_read_b128 v[72:75], v9 offset:8192
  v_mfma_f32_32x32x16_bf16 v[44:59], v[76:79], v[96:99], v[44:59]
  buffer_load_dwordx4 v[236:239], v4, s[28:31], s41 offen offset:3072 sc1
  ds_read_b128 v[64:67], v8 offset:9216
  s_waitcnt lgkmcnt(5)
  v_mfma_f32_32x32x16_bf16 v[28:43], v[104:107], v[60:63], v[28:43]
  ds_read_b128 v[96:99], v9 offset:9216
  v_mfma_f32_32x32x16_bf16 v[44:59], v[104:107], v[16:19], v[44:59]
  ds_read_b128 v[76:79], v8 offset:24576
  s_waitcnt lgkmcnt(5)
  v_mfma_f32_32x32x16_bf16 v[28:43], v[108:111], v[100:103], v[28:43]
  s_xor_b32 s41, s41, 4096
  buffer_load_dwordx4 v[240:243], v4, s[28:31], s41 offen offset:0 sc1
  ds_read_b128 v[60:63], v9 offset:24576
  v_mfma_f32_32x32x16_bf16 v[44:59], v[108:111], v[68:71], v[44:59]
  ds_read_b128 v[16:19], v8 offset:25600
  s_waitcnt lgkmcnt(5)
  v_mfma_f32_32x32x16_bf16 v[28:43], v[80:83], v[24:27], v[28:43]
  ds_read_b128 v[104:107], v9 offset:25600
  v_mfma_f32_32x32x16_bf16 v[44:59], v[80:83], v[72:75], v[44:59]
  buffer_load_dwordx4 v[244:247], v4, s[28:31], s41 offen offset:1024 sc1
  ds_read_b128 v[100:103], v8 offset:10240
  s_waitcnt lgkmcnt(5)
  v_mfma_f32_32x32x16_bf16 v[28:43], v[84:87], v[64:67], v[28:43]
  ds_read_b128 v[68:71], v9 offset:10240
  v_mfma_f32_32x32x16_bf16 v[44:59], v[84:87], v[96:99], v[44:59]
  ds_read_b128 v[108:111], v8 offset:11264
  s_waitcnt lgkmcnt(5)
  v_mfma_f32_32x32x16_bf16 v[28:43], v[112:115], v[76:79], v[28:43]
  buffer_load_dwordx4 v[248:251], v4, s[28:31], s41 offen offset:2048 sc1
  ds_read_b128 v[24:27], v9 offset:11264
  v_mfma_f32_32x32x16_bf16 v[44:59], v[112:115], v[60:63], v[44:59]
  ds_read_b128 v[72:75], v8 offset:26624
  s_waitcnt lgkmcnt(5)
  v_mfma_f32_32x32x16_bf16 v[28:43], v[116:119], v[16:19], v[28:43]
  ds_read_b128 v[60:63], v9 offset:26624
  v_mfma_f32_32x32x16_bf16 v[44:59], v[116:119], v[104:107], v[44:59]
  buffer_load_dwordx4 v[252:255], v4, s[28:31], s41 offen offset:3072 sc1
  ds_read_b128 v[112:115], v8 offset:27648
  s_waitcnt lgkmcnt(5)
  v_mfma_f32_32x32x16_bf16 v[28:43], v[88:91], v[100:103], v[28:43]
  ds_read_b128 v[16:19], v9 offset:27648
  v_mfma_f32_32x32x16_bf16 v[44:59], v[88:91], v[68:71], v[44:59]
  ds_read_b128 v[104:107], v6 offset:0
  s_waitcnt lgkmcnt(5)
  v_mfma_f32_32x32x16_bf16 v[28:43], v[92:95], v[108:111], v[28:43]
  ds_read_b128 v[116:119], v6 offset:1024
  v_mfma_f32_32x32x16_bf16 v[44:59], v[92:95], v[24:27], v[44:59]
  ds_read_b128 v[108:111], v6 offset:2048
  s_waitcnt lgkmcnt(5)
  v_mfma_f32_32x32x16_bf16 v[28:43], v[120:123], v[72:75], v[28:43]
  ds_read_b128 v[24:27], v6 offset:3072
  v_mfma_f32_32x32x16_bf16 v[44:59], v[120:123], v[60:63], v[44:59]
  ds_read_b128 v[60:63], v6 offset:8192
  s_waitcnt lgkmcnt(5)
  v_mfma_f32_32x32x16_bf16 v[28:43], v[124:127], v[112:115], v[28:43]
  ds_read_b128 v[120:123], v6 offset:9216
  v_mfma_f32_32x32x16_bf16 v[44:59], v[124:127], v[16:19], v[44:59]
  ds_read_b128 v[112:115], v6 offset:10240
  s_waitcnt lgkmcnt(5)
  v_mfma_f32_32x32x16_bf16 v[64:79], v[128:131], v[104:107], 0
  ds_read_b128 v[16:19], v6 offset:11264
  v_mfma_f32_32x32x16_bf16 v[64:79], v[132:135], v[116:119], v[64:79]
  ds_read_b128 v[124:127], v6 offset:16384
  s_waitcnt lgkmcnt(5)
  v_mfma_f32_32x32x16_bf16 v[64:79], v[136:139], v[108:111], v[64:79]
  s_nop 1
  ds_write_b128 v10, v[28:31] offset:0
  ds_read_b128 v[104:107], v6 offset:17408
  v_mfma_f32_32x32x16_bf16 v[64:79], v[140:143], v[24:27], v[64:79]
  ds_write_b128 v10, v[32:35] offset:1024
  ds_read_b128 v[116:119], v6 offset:18432
  s_waitcnt lgkmcnt(7)
  v_mfma_f32_32x32x16_bf16 v[64:79], v[144:147], v[60:63], v[64:79]
  ds_write_b128 v10, v[36:39] offset:2048
  ds_read_b128 v[108:111], v6 offset:19456
  v_mfma_f32_32x32x16_bf16 v[64:79], v[148:151], v[120:123], v[64:79]
  ds_write_b128 v10, v[40:43] offset:3072
  ds_read_b128 v[24:27], v6 offset:24576
  s_waitcnt lgkmcnt(9)
  v_mfma_f32_32x32x16_bf16 v[64:79], v[152:155], v[112:115], v[64:79]
  ds_write_b128 v10, v[44:47] offset:4096
  ds_read_b128 v[60:63], v6 offset:25600
  v_mfma_f32_32x32x16_bf16 v[64:79], v[156:159], v[16:19], v[64:79]
  ds_write_b128 v10, v[48:51] offset:5120
  ds_read_b128 v[120:123], v6 offset:26624
  s_waitcnt lgkmcnt(10)
  v_mfma_f32_32x32x16_bf16 v[64:79], v[160:163], v[124:127], v[64:79]
  ds_write_b128 v10, v[52:55] offset:6144
  ds_read_b128 v[112:115], v6 offset:27648
  v_mfma_f32_32x32x16_bf16 v[64:79], v[164:167], v[104:107], v[64:79]
  ds_write_b128 v10, v[56:59] offset:7168
  s_mov_b64 exec, 1
  ds_add_u32 v1, v2 offset:30140
  s_mov_b64 exec, -1
  ds_read_b128 v[16:19], v6 offset:32768
  s_waitcnt lgkmcnt(11)
  v_mfma_f32_32x32x16_bf16 v[64:79], v[168:171], v[116:119], v[64:79]
  ds_read_b128 v[124:127], v6 offset:33792
  v_mfma_f32_32x32x16_bf16 v[64:79], v[172:175], v[108:111], v[64:79]
  ds_read_b128 v[104:107], v6 offset:34816
  s_waitcnt lgkmcnt(9)
  v_mfma_f32_32x32x16_bf16 v[64:79], v[176:179], v[24:27], v[64:79]
  ds_read_b128 v[116:119], v6 offset:35840
  v_mfma_f32_32x32x16_bf16 v[64:79], v[180:183], v[60:63], v[64:79]
  ds_read_b128 v[108:111], v6 offset:40960
  s_waitcnt lgkmcnt(7)
  v_mfma_f32_32x32x16_bf16 v[64:79], v[184:187], v[120:123], v[64:79]
  ds_read_b128 v[24:27], v6 offset:41984
  v_mfma_f32_32x32x16_bf16 v[64:79], v[188:191], v[112:115], v[64:79]
  ds_read_b128 v[60:63], v6 offset:43008
  s_waitcnt lgkmcnt(5)
  v_mfma_f32_32x32x16_bf16 v[64:79], v[192:195], v[16:19], v[64:79]
  ds_read_b128 v[120:123], v6 offset:44032
  v_mfma_f32_32x32x16_bf16 v[64:79], v[196:199], v[124:127], v[64:79]
  ds_read_b128 v[112:115], v6 offset:49152
  s_waitcnt lgkmcnt(5)
  v_mfma_f32_32x32x16_bf16 v[64:79], v[200:203], v[104:107], v[64:79]
  ds_read_b128 v[16:19], v6 offset:50176
  v_mfma_f32_32x32x16_bf16 v[64:79], v[204:207], v[116:119], v[64:79]
  ds_read_b128 v[124:127], v6 offset:51200
  s_waitcnt vmcnt(11)
  s_waitcnt lgkmcnt(5)
  v_mfma_f32_32x32x16_bf16 v[64:79], v[208:211], v[108:111], v[64:79]
  v_mfma_f32_16x16x32_bf16 v[20:23], v[12:15], v[208:211], v[20:23]
  ds_read_b128 v[104:107], v6 offset:52224
  s_waitcnt vmcnt(10)
  v_mfma_f32_32x32x16_bf16 v[64:79], v[212:215], v[24:27], v[64:79]
  v_mfma_f32_16x16x32_bf16 v[20:23], v[12:15], v[212:215], v[20:23]
  ds_read_b128 v[116:119], v6 offset:57344
  s_waitcnt vmcnt(9)
  s_waitcnt lgkmcnt(5)
  v_mfma_f32_32x32x16_bf16 v[64:79], v[216:219], v[60:63], v[64:79]
  v_mfma_f32_16x16x32_bf16 v[20:23], v[12:15], v[216:219], v[20:23]
  ds_read_b128 v[108:111], v6 offset:58368
  s_waitcnt vmcnt(8)
  v_mfma_f32_32x32x16_bf16 v[64:79], v[220:223], v[120:123], v[64:79]
  v_mfma_f32_16x16x32_bf16 v[20:23], v[12:15], v[220:223], v[20:23]
  ds_read_b128 v[24:27], v6 offset:59392
  ds_read_b32 v3, v1 offset:30160
  s_waitcnt vmcnt(7)
  s_waitcnt lgkmcnt(6)
  v_mfma_f32_32x32x16_bf16 v[64:79], v[224:227], v[112:115], v[64:79]
  v_mfma_f32_16x16x32_bf16 v[20:23], v[12:15], v[224:227], v[20:23]
  ds_read_b128 v[60:63], v6 offset:60416
  s_waitcnt vmcnt(6)
  v_mfma_f32_32x32x16_bf16 v[64:79], v[228:231], v[16:19], v[64:79]
  v_mfma_f32_16x16x32_bf16 v[20:23], v[12:15], v[228:231], v[20:23]
  ds_read_b128 v[120:123], v6 offset:4096
  s_waitcnt vmcnt(5)
  s_waitcnt lgkmcnt(6)
  v_mfma_f32_32x32x16_bf16 v[64:79], v[232:235], v[124:127], v[64:79]
  v_mfma_f32_16x16x32_bf16 v[20:23], v[12:15], v[232:235], v[20:23]
  ds_read_b128 v[112:115], v6 offset:5120
  s_waitcnt vmcnt(4)
  v_mfma_f32_32x32x16_bf16 v[64:79], v[236:239], v[104:107], v[64:79]
  v_mfma_f32_16x16x32_bf16 v[20:23], v[12:15], v[236:239], v[20:23]
  ds_read_b128 v[16:19], v6 offset:6144
  s_waitcnt vmcnt(3)
  s_waitcnt lgkmcnt(6)
  v_mfma_f32_32x32x16_bf16 v[64:79], v[240:243], v[116:119], v[64:79]
  v_mfma_f32_16x16x32_bf16 v[20:23], v[12:15], v[240:243], v[20:23]
  ds_read_b128 v[124:127], v6 offset:7168
  s_waitcnt vmcnt(2)
  v_mfma_f32_32x32x16_bf16 v[64:79], v[244:247], v[108:111], v[64:79]
  v_mfma_f32_16x16x32_bf16 v[20:23], v[12:15], v[244:247], v[20:23]
  ds_read_b128 v[104:107], v6 offset:12288
  s_waitcnt lgkmcnt(6)
  v_readfirstlane_b32 s78, v3
  s_nop 0
  s_cmp_ge_u32 s78, 4
  s_cbranch_scc1 OK_100
  s_mov_b32 s79, 1000000
SP_101:
  ds_read_b32 v3, v1 offset:30160
  s_waitcnt lgkmcnt(0)
  v_readfirstlane_b32 s78, v3
  s_nop 0
  s_cmp_ge_u32 s78, 4
  s_cbranch_scc1 SPE_102
  s_sub_u32 s79, s79, 1
  s_cbranch_scc0 SP_101
SPE_102:
OK_100:
  s_waitcnt vmcnt(1)
  s_waitcnt lgkmcnt(5)
  v_mfma_f32_32x32x16_bf16 v[64:79], v[248:251], v[24:27], v[64:79]
  v_mfma_f32_16x16x32_bf16 v[20:23], v[12:15], v[248:251], v[20:23]
  ds_read_b128 v[116:119], v6 offset:13312
  s_waitcnt vmcnt(0)
  v_mfma_f32_32x32x16_bf16 v[64:79], v[252:255], v[60:63], v[64:79]
  v_mfma_f32_16x16x32_bf16 v[20:23], v[12:15], v[252:255], v[20:23]
  ds_read_b128 v[108:111], v6 offset:14336
  s_waitcnt lgkmcnt(5)
  v_mfma_f32_32x32x16_bf16 v[44:59], v[128:131], v[120:123], 0
  ds_read_b128 v[24:27], v6 offset:15360
  v_mfma_f32_32x32x16_bf16 v[44:59], v[132:135], v[112:115], v[44:59]
  s_mov_b64 exec, 0xffff
  s_nop 1
  ds_write2_b32 v7, v20, v21 offset0:32 offset1:48
  s_mov_b64 exec, -1
  ds_read_b128 v[80:83], v5 offset:0
  ds_read_b128 v[84:87], v5 offset:32
  ds_read_b128 v[88:91], v5 offset:64
  ds_read_b128 v[92:95], v5 offset:96
  ds_read_b64 v[102:103], v11 offset:28480
  ds_read_b128 v[60:63], v6 offset:20480
  s_waitcnt lgkmcnt(11)
  v_mfma_f32_32x32x16_bf16 v[44:59], v[136:139], v[16:19], v[44:59]
  ds_read_b128 v[120:123], v6 offset:21504
  v_mfma_f32_32x32x16_bf16 v[44:59], v[140:143], v[124:127], v[44:59]
  ds_read_b128 v[112:115], v6 offset:22528
  s_waitcnt lgkmcnt(11)
  v_mfma_f32_32x32x16_bf16 v[44:59], v[144:147], v[104:107], v[44:59]
  s_waitcnt lgkmcnt(3)
  v_fma_f32 v64, -v80, v102, v64
  v_fma_f32 v66, -v82, v102, v66
  v_fma_f32 v65, -v81, v102, v65
  v_fma_f32 v67, -v83, v102, v67
  v_mul_f32 v64, v64, v103
  v_mul_f32 v66, v66, v103
  v_mul_f32 v65, v65, v103
  ds_read_b128 v[16:19], v6 offset:23552
  v_mfma_f32_32x32x16_bf16 v[44:59], v[148:151], v[116:119], v[44:59]
  v_mul_f32 v67, v67, v103
  v_fma_f32 v96, -v64, v64, -s80
  v_fma_f32 v98, -v66, v66, -s80
  v_fma_f32 v97, -v65, v65, -s80
  v_fma_f32 v99, -v67, v67, -s80
  v_mul_f32 v96, v96, v64
  v_mul_f32 v98, v98, v66
  ds_read_b128 v[124:127], v6 offset:28672
  v_mfma_f32_32x32x16_bf16 v[44:59], v[152:155], v[108:111], v[44:59]
  v_mul_f32 v97, v97, v65
  v_mul_f32 v99, v99, v67
  v_exp_f32 v96, v96
  v_exp_f32 v98, v98
  ds_read_b128 v[104:107], v6 offset:29696
  v_mfma_f32_32x32x16_bf16 v[44:59], v[156:159], v[24:27], v[44:59]
  v_exp_f32 v97, v97
  v_exp_f32 v99, v99
  v_fma_f32 v96, v96, s82, s82
  v_fma_f32 v98, v98, s82, s82
  v_fma_f32 v97, v97, s82, s82
  v_fma_f32 v99, v99, s82, s82
  ds_read_b128 v[116:119], v6 offset:30720
  s_waitcnt lgkmcnt(5)
  v_mfma_f32_32x32x16_bf16 v[44:59], v[160:163], v[60:63], v[44:59]
  v_rcp_f32 v96, v96
  v_rcp_f32 v98, v98
  v_rcp_f32 v97, v97
  ds_read_b128 v[108:111], v6 offset:31744
  v_mfma_f32_32x32x16_bf16 v[44:59], v[164:167], v[120:123], v[44:59]
  v_rcp_f32 v99, v99
  v_mul_f32 v96, v96, v64
  v_mul_f32 v98, v98, v66
  v_mul_f32 v97, v97, v65
  v_mul_f32 v99, v99, v67
  v_cvt_pk_bf16_f32 v64, v96, v97
  v_cvt_pk_bf16_f32 v65, v98, v99
  ds_read_b128 v[24:27], v6 offset:36864
  s_waitcnt lgkmcnt(5)
  v_mfma_f32_32x32x16_bf16 v[44:59], v[168:171], v[112:115], v[44:59]
  v_fma_f32 v68, -v84, v102, v68
  v_fma_f32 v70, -v86, v102, v70
  v_fma_f32 v69, -v85, v102, v69
  v_fma_f32 v71, -v87, v102, v71
  v_mul_f32 v68, v68, v103
  v_mul_f32 v70, v70, v103
  v_mul_f32 v69, v69, v103
  v_mul_f32 v71, v71, v103
  ds_read_b128 v[60:63], v6 offset:37888
  v_mfma_f32_32x32x16_bf16 v[44:59], v[172:175], v[16:19], v[44:59]
  v_fma_f32 v96, -v68, v68, -s80
  v_fma_f32 v98, -v70, v70, -s80
  v_fma_f32 v97, -v69, v69, -s80
  v_fma_f32 v99, -v71, v71, -s80
  v_mul_f32 v96, v96, v68
  v_mul_f32 v98, v98, v70
  v_mul_f32 v97, v97, v69
  ds_read_b128 v[120:123], v6 offset:38912
  s_waitcnt lgkmcnt(5)
  v_mfma_f32_32x32x16_bf16 v[44:59], v[176:179], v[124:127], v[44:59]
  v_mul_f32 v99, v99, v71
  v_exp_f32 v96, v96
  v_exp_f32 v98, v98
  v_exp_f32 v97, v97
  ds_read_b128 v[112:115], v6 offset:39936
  v_mfma_f32_32x32x16_bf16 v[44:59], v[180:183], v[104:107], v[44:59]
  v_exp_f32 v99, v99
  v_fma_f32 v96, v96, s82, s82
  v_fma_f32 v98, v98, s82, s82
  v_fma_f32 v97, v97, s82, s82
  v_fma_f32 v99, v99, s82, s82
  ds_read_b128 v[16:19], v6 offset:45056
  s_waitcnt lgkmcnt(5)
  v_mfma_f32_32x32x16_bf16 v[44:59], v[184:187], v[116:119], v[44:59]
  v_rcp_f32 v96, v96
  v_rcp_f32 v98, v98
  v_rcp_f32 v97, v97
  v_rcp_f32 v99, v99
  ds_read_b128 v[124:127], v6 offset:46080
  v_mfma_f32_32x32x16_bf16 v[44:59], v[188:191], v[108:111], v[44:59]
  v_mul_f32 v96, v96, v68
  v_mul_f32 v98, v98, v70
  v_mul_f32 v97, v97, v69
  v_mul_f32 v99, v99, v71
  v_cvt_pk_bf16_f32 v66, v96, v97
  v_cvt_pk_bf16_f32 v67, v98, v99
  buffer_store_dwordx4 v[64:67], v4, s[28:31], s48 offen offset:0 sc1
  ds_read_b128 v[104:107], v6 offset:47104
  s_waitcnt lgkmcnt(5)
  v_mfma_f32_32x32x16_bf16 v[44:59], v[192:195], v[24:27], v[44:59]
  v_fma_f32 v72, -v88, v102, v72
  v_fma_f32 v74, -v90, v102, v74
  v_fma_f32 v73, -v89, v102, v73
  v_fma_f32 v75, -v91, v102, v75
  v_mul_f32 v72, v72, v103
  v_mul_f32 v74, v74, v103
  v_mul_f32 v73, v73, v103
  ds_read_b128 v[116:119], v6 offset:48128
  v_mfma_f32_32x32x16_bf16 v[44:59], v[196:199], v[60:63], v[44:59]
  v_mul_f32 v75, v75, v103
  v_fma_f32 v96, -v72, v72, -s80
  v_fma_f32 v98, -v74, v74, -s80
  v_fma_f32 v97, -v73, v73, -s80
  v_fma_f32 v99, -v75, v75, -s80
  v_mul_f32 v96, v96, v72
  v_mul_f32 v98, v98, v74
  ds_read_b128 v[108:111], v6 offset:53248
  s_waitcnt lgkmcnt(5)
  v_mfma_f32_32x32x16_bf16 v[44:59], v[200:203], v[120:123], v[44:59]
  v_mul_f32 v97, v97, v73
  v_mul_f32 v99, v99, v75
  v_exp_f32 v96, v96
  v_exp_f32 v98, v98
  ds_read_b128 v[24:27], v6 offset:54272
  v_mfma_f32_32x32x16_bf16 v[44:59], v[204:207], v[112:115], v[44:59]
  v_exp_f32 v97, v97
  v_exp_f32 v99, v99
  v_fma_f32 v96, v96, s82, s82
  v_fma_f32 v98, v98, s82, s82
  v_fma_f32 v97, v97, s82, s82
  v_fma_f32 v99, v99, s82, s82
  ds_read_b128 v[60:63], v6 offset:55296
  s_waitcnt lgkmcnt(5)
  v_mfma_f32_32x32x16_bf16 v[44:59], v[208:211], v[16:19], v[44:59]
  v_rcp_f32 v96, v96
  v_rcp_f32 v98, v98
  v_rcp_f32 v97, v97
  ds_read_b128 v[120:123], v6 offset:56320
  v_mfma_f32_32x32x16_bf16 v[44:59], v[212:215], v[124:127], v[44:59]
  v_rcp_f32 v99, v99
  v_mul_f32 v96, v96, v72
  v_mul_f32 v98, v98, v74
  v_mul_f32 v97, v97, v73
  v_mul_f32 v99, v99, v75
  v_cvt_pk_bf16_f32 v72, v96, v97
  v_cvt_pk_bf16_f32 v73, v98, v99
  ds_read_b128 v[112:115], v6 offset:61440
  s_waitcnt lgkmcnt(5)
  v_mfma_f32_32x32x16_bf16 v[44:59], v[216:219], v[104:107], v[44:59]
  v_fma_f32 v76, -v92, v102, v76
  v_fma_f32 v78, -v94, v102, v78
  v_fma_f32 v77, -v93, v102, v77
  v_fma_f32 v79, -v95, v102, v79
  v_mul_f32 v76, v76, v103
  v_mul_f32 v78, v78, v103
  v_mul_f32 v77, v77, v103
  v_mul_f32 v79, v79, v103
  ds_read_b128 v[16:19], v6 offset:62464
  v_mfma_f32_32x32x16_bf16 v[44:59], v[220:223], v[116:119], v[44:59]
  v_fma_f32 v96, -v76, v76, -s80
  v_fma_f32 v98, -v78, v78, -s80
  v_fma_f32 v97, -v77, v77, -s80
  v_fma_f32 v99, -v79, v79, -s80
  v_mul_f32 v96, v96, v76
  v_mul_f32 v98, v98, v78
  v_mul_f32 v97, v97, v77
  ds_read_b128 v[124:127], v6 offset:63488
  s_waitcnt lgkmcnt(5)
  v_mfma_f32_32x32x16_bf16 v[44:59], v[224:227], v[108:111], v[44:59]
  v_mul_f32 v99, v99, v79
  v_exp_f32 v96, v96
  v_exp_f32 v98, v98
  v_exp_f32 v97, v97
  ds_read_b128 v[104:107], v6 offset:64512
  v_mfma_f32_32x32x16_bf16 v[44:59], v[228:231], v[24:27], v[44:59]
  v_exp_f32 v99, v99
  v_fma_f32 v96, v96, s82, s82
  v_fma_f32 v98, v98, s82, s82
  v_fma_f32 v97, v97, s82, s82
  v_fma_f32 v99, v99, s82, s82
  s_waitcnt lgkmcnt(4)
  v_mfma_f32_32x32x16_bf16 v[44:59], v[232:235], v[60:63], v[44:59]
  v_rcp_f32 v96, v96
  v_rcp_f32 v98, v98
  v_rcp_f32 v97, v97
  v_rcp_f32 v99, v99
  v_mfma_f32_32x32x16_bf16 v[44:59], v[236:239], v[120:123], v[44:59]
  v_mul_f32 v96, v96, v76
  v_mul_f32 v98, v98, v78
  v_mul_f32 v97, v97, v77
  v_mul_f32 v99, v99, v79
  v_cvt_pk_bf16_f32 v74, v96, v97
  v_cvt_pk_bf16_f32 v75, v98, v99
  buffer_store_dwordx4 v[72:75], v4, s[28:31], s48 offen offset:1024 sc1
  s_waitcnt lgkmcnt(2)
  v_mfma_f32_32x32x16_bf16 v[44:59], v[240:243], v[112:115], v[44:59]
  v_mfma_f32_32x32x16_bf16 v[44:59], v[244:247], v[16:19], v[44:59]
  s_waitcnt lgkmcnt(0)
  v_mfma_f32_32x32x16_bf16 v[44:59], v[248:251], v[124:127], v[44:59]
  v_mfma_f32_32x32x16_bf16 v[44:59], v[252:255], v[104:107], v[44:59]
  ds_read_b64 v[102:103], v11 offset:28736
  s_waitcnt lgkmcnt(0)
  v_lshlrev_b32 v27, 7, v0
  s_nop 8
  v_fma_f32 v44, -v80, v102, v44
  v_fma_f32 v46, -v82, v102, v46
  v_fma_f32 v45, -v81, v102, v45
  v_fma_f32 v47, -v83, v102, v47
  v_mul_f32 v44, v44, v103
  v_mul_f32 v46, v46, v103
  v_mul_f32 v45, v45, v103
  v_mul_f32 v47, v47, v103
  v_fma_f32 v96, -v44, v44, -s80
  v_fma_f32 v98, -v46, v46, -s80
  v_fma_f32 v97, -v45, v45, -s80
  v_fma_f32 v99, -v47, v47, -s80
  v_mul_f32 v96, v96, v44
  v_mul_f32 v98, v98, v46
  v_mul_f32 v97, v97, v45
  v_mul_f32 v99, v99, v47
  v_exp_f32 v96, v96
  v_exp_f32 v98, v98
  v_exp_f32 v97, v97
  v_exp_f32 v99, v99
  v_fma_f32 v96, v96, s82, s82
  v_fma_f32 v98, v98, s82, s82
  v_fma_f32 v97, v97, s82, s82
  v_fma_f32 v99, v99, s82, s82
  v_rcp_f32 v96, v96
  v_rcp_f32 v98, v98
  v_rcp_f32 v97, v97
  v_rcp_f32 v99, v99
  v_mul_f32 v96, v96, v44
  v_mul_f32 v98, v98, v46
  v_mul_f32 v97, v97, v45
  v_mul_f32 v99, v99, v47
  v_cvt_pk_bf16_f32 v44, v96, v97
  v_cvt_pk_bf16_f32 v45, v98, v99
  v_fma_f32 v48, -v84, v102, v48
  v_fma_f32 v50, -v86, v102, v50
  v_fma_f32 v49, -v85, v102, v49
  v_fma_f32 v51, -v87, v102, v51
  v_mul_f32 v48, v48, v103
  v_mul_f32 v50, v50, v103
  v_mul_f32 v49, v49, v103
  v_mul_f32 v51, v51, v103
  v_fma_f32 v96, -v48, v48, -s80
  v_fma_f32 v98, -v50, v50, -s80
  v_fma_f32 v97, -v49, v49, -s80
  v_fma_f32 v99, -v51, v51, -s80
  v_mul_f32 v96, v96, v48
  v_mul_f32 v98, v98, v50
  v_mul_f32 v97, v97, v49
  v_mul_f32 v99, v99, v51
  v_exp_f32 v96, v96
  v_exp_f32 v98, v98
  v_exp_f32 v97, v97
  v_exp_f32 v99, v99
  v_fma_f32 v96, v96, s82, s82
  v_fma_f32 v98, v98, s82, s82
  v_fma_f32 v97, v97, s82, s82
  v_fma_f32 v99, v99, s82, s82
  v_rcp_f32 v96, v96
  v_rcp_f32 v98, v98
  v_rcp_f32 v97, v97
  v_rcp_f32 v99, v99
  v_mul_f32 v96, v96, v48
  v_mul_f32 v98, v98, v50
  v_mul_f32 v97, v97, v49
  v_mul_f32 v99, v99, v51
  v_cvt_pk_bf16_f32 v46, v96, v97
  v_cvt_pk_bf16_f32 v47, v98, v99
  buffer_store_dwordx4 v[44:47], v4, s[28:31], s49 offen offset:0 sc1
  s_waitcnt vmcnt(1)
  v_mov_b32 v3, s68
  s_mov_b64 exec, 1
  s_cmp_lg_u32 s24, 1
  s_cbranch_scc1 FS_103
  buffer_store_dword v3, off, s[28:31], s46 offset:384
  s_branch FE_104
FS_103:
  buffer_store_dword v3, off, s[28:31], s46 offset:384 sc1
FE_104:
  s_mov_b64 exec, -1
  v_fma_f32 v52, -v88, v102, v52
  v_fma_f32 v54, -v90, v102, v54
  v_fma_f32 v53, -v89, v102, v53
  v_fma_f32 v55, -v91, v102, v55
  v_mul_f32 v52, v52, v103
  v_mul_f32 v54, v54, v103
  v_mul_f32 v53, v53, v103
  v_mul_f32 v55, v55, v103
  v_fma_f32 v96, -v52, v52, -s80
  v_fma_f32 v98, -v54, v54, -s80
  v_fma_f32 v97, -v53, v53, -s80
  v_fma_f32 v99, -v55, v55, -s80
  v_mul_f32 v96, v96, v52
  v_mul_f32 v98, v98, v54
  v_mul_f32 v97, v97, v53
  v_mul_f32 v99, v99, v55
  v_exp_f32 v96, v96
  v_exp_f32 v98, v98
  v_exp_f32 v97, v97
  v_exp_f32 v99, v99
  v_fma_f32 v96, v96, s82, s82
  v_fma_f32 v98, v98, s82, s82
  v_fma_f32 v97, v97, s82, s82
  v_fma_f32 v99, v99, s82, s82
  v_rcp_f32 v96, v96
  v_rcp_f32 v98, v98
  v_rcp_f32 v97, v97
  v_rcp_f32 v99, v99
  v_mul_f32 v96, v96, v52
  v_mul_f32 v98, v98, v54
  v_mul_f32 v97, v97, v53
  v_mul_f32 v99, v99, v55
  v_cvt_pk_bf16_f32 v52, v96, v97
  v_cvt_pk_bf16_f32 v53, v98, v99
  v_fma_f32 v56, -v92, v102, v56
  v_fma_f32 v58, -v94, v102, v58
  v_fma_f32 v57, -v93, v102, v57
  v_fma_f32 v59, -v95, v102, v59
  v_mul_f32 v56, v56, v103
  v_mul_f32 v58, v58, v103
  v_mul_f32 v57, v57, v103
  v_mul_f32 v59, v59, v103
  v_fma_f32 v96, -v56, v56, -s80
  v_fma_f32 v98, -v58, v58, -s80
  v_fma_f32 v97, -v57, v57, -s80
  v_fma_f32 v99, -v59, v59, -s80
  v_mul_f32 v96, v96, v56
  v_mul_f32 v98, v98, v58
  v_mul_f32 v97, v97, v57
  v_mul_f32 v99, v99, v59
  v_exp_f32 v96, v96
  v_exp_f32 v98, v98
  v_exp_f32 v97, v97
  v_exp_f32 v99, v99
  v_fma_f32 v96, v96, s82, s82
  v_fma_f32 v98, v98, s82, s82
  v_fma_f32 v97, v97, s82, s82
  v_fma_f32 v99, v99, s82, s82
  v_rcp_f32 v96, v96
  v_rcp_f32 v98, v98
  v_rcp_f32 v97, v97
  v_rcp_f32 v99, v99
  v_mul_f32 v96, v96, v56
  v_mul_f32 v98, v98, v58
  v_mul_f32 v97, v97, v57
  v_mul_f32 v99, v99, v59
  v_cvt_pk_bf16_f32 v54, v96, v97
  v_cvt_pk_bf16_f32 v55, v98, v99
  buffer_store_dwordx4 v[52:55], v4, s[28:31], s49 offen offset:1024 sc1
  s_and_b32 s70, s3, 1
  s_lshr_b32 s71, s3, 1
  v_and_b32 v20, 15, v0
  v_lshrrev_b32 v21, 4, v0
  v_lshrrev_b32 v22, 5, v0
  v_lshlrev_b32 v22, 10, v22
  v_lshl_add_u32 v22, v20, 4, v22
  v_and_b32 v23, 1, v21
  v_lshl_add_u32 v22, v23, 3, v22
  s_andn2_b32 s78, s4, 1
  s_lshl_b32 s78, s78, 13
  s_lshl_b32 s79, s71, 11
  s_add_u32 s78, s78, s79
  s_lshl_b32 s79, s70, 8
  s_add_u32 s78, s78, s79
  s_add_u32 s78, s78, 32768
  v_add_u32 v22, s78, v22
  ds_read_b64 v[64:65], v22 offset:0
  ds_read_b64 v[66:67], v22 offset:512
  ds_read_b64 v[68:69], v22 offset:4096
  ds_read_b64 v[70:71], v22 offset:4608
  v_lshlrev_b32 v23, 7, v20
  v_lshl_add_u32 v23, v21, 4, v23
  s_lshl_b32 s78, s70, 11
  s_lshl_b32 s79, s71, 6
  s_add_u32 s78, s78, s79
  v_add_u32 v23, s78, v23
  ds_read_b128 v[72:75], v23 offset:16640
  ds_read_b128 v[76:79], v23 offset:20736
  v_bfe_u32 v24, v0, 2, 2
  v_lshl_add_u32 v24, v21, 3, v24
  v_lshlrev_b32 v24, 7, v24
  v_and_b32 v16, 3, v0
  v_lshl_add_u32 v24, v16, 3, v24
  s_lshl_b32 s78, s71, 12
  s_lshl_b32 s79, s70, 5
  s_add_u32 s78, s78, s79
  v_add_u32 v24, s78, v24
  v_lshlrev_b32 v16, 4, v20
  v_lshl_add_u32 v16, v21, 10, v16
  s_lshl_b32 s78, s71, 12
  s_lshl_b32 s79, s70, 8
  s_add_u32 s78, s78, s79
  s_add_u32 s78, s78, 98304
  v_add_u32 v16, s78, v16
  v_lshlrev_b32 v17, 10, v20
  v_lshl_add_u32 v17, v21, 4, v17
  s_lshl_b32 s72, s5, 16
  s_lshl_b32 s79, s70, 14
  s_add_u32 s72, s72, s79
  s_lshl_b32 s79, s4, 7
  s_add_u32 s72, s72, s79
  s_lshl_b32 s79, s71, 6
  s_add_u32 s72, s72, s79
  s_mov_b32 s32, s0
  s_mov_b32 s33, s1
  s_mov_b32 s34, 2097152
  s_mov_b32 s35, 0x20000
  s_waitcnt vmcnt(0)
  v_mov_b32 v3, s68
  s_mov_b64 exec, 1
  s_cmp_lg_u32 s24, 1
  s_cbranch_scc1 FS_105
  buffer_store_dword v3, off, s[28:31], s46 offset:512
  s_branch FE_106
FS_105:
  buffer_store_dword v3, off, s[28:31], s46 offset:512 sc1
FE_106:
  s_mov_b64 exec, -1
  s_setprio 0
  s_cmp_lg_u32 s3, 0
  s_cbranch_scc1 SCX_109
  s_add_u32 s92, s90, s27
  s_addc_u32 s93, s91, 0
  s_mov_b32 s79, 200000
SC_107:
  s_load_dwordx8 s[8:15], s[92:93], 1024 glc
  s_load_dwordx8 s[16:23], s[92:93], 1152 glc
  s_load_dwordx8 s[52:59], s[92:93], 1280 glc
  s_load_dwordx8 s[60:67], s[92:93], 1408 glc
  s_waitcnt lgkmcnt(0)
  s_xor_b64 s[8:9], s[8:9], s[68:69]
  s_xor_b64 s[10:11], s[10:11], s[68:69]
  s_xor_b64 s[12:13], s[12:13], s[68:69]
  s_xor_b64 s[14:15], s[14:15], s[68:69]
  s_xor_b64 s[16:17], s[16:17], s[68:69]
  s_xor_b64 s[18:19], s[18:19], s[68:69]
  s_xor_b64 s[20:21], s[20:21], s[68:69]
  s_xor_b64 s[22:23], s[22:23], s[68:69]
  s_xor_b64 s[52:53], s[52:53], s[68:69]
  s_xor_b64 s[54:55], s[54:55], s[68:69]
  s_xor_b64 s[56:57], s[56:57], s[68:69]
  s_xor_b64 s[58:59], s[58:59], s[68:69]
  s_xor_b64 s[60:61], s[60:61], s[68:69]
  s_xor_b64 s[62:63], s[62:63], s[68:69]
  s_xor_b64 s[64:65], s[64:65], s[68:69]
  s_xor_b64 s[66:67], s[66:67], s[68:69]
  s_or_b64 s[8:9], s[8:9], s[10:11]
  s_or_b64 s[8:9], s[8:9], s[12:13]
  s_or_b64 s[8:9], s[8:9], s[14:15]
  s_or_b64 s[8:9], s[8:9], s[16:17]
  s_or_b64 s[8:9], s[8:9], s[18:19]
  s_or_b64 s[8:9], s[8:9], s[20:21]
  s_or_b64 s[8:9], s[8:9], s[22:23]
  s_or_b64 s[8:9], s[8:9], s[52:53]
  s_or_b64 s[8:9], s[8:9], s[54:55]
  s_or_b64 s[8:9], s[8:9], s[56:57]
  s_or_b64 s[8:9], s[8:9], s[58:59]
  s_or_b64 s[8:9], s[8:9], s[60:61]
  s_or_b64 s[8:9], s[8:9], s[62:63]
  s_or_b64 s[8:9], s[8:9], s[64:65]
  s_or_b64 s[8:9], s[8:9], s[66:67]
  s_cbranch_scc0 SCE_108
  s_sleep 2
  s_sub_u32 s79, s79, 1
  s_cbranch_scc0 SC_107
SCE_108:
  s_mov_b64 exec, 1
  ds_add_u32 v1, v2 offset:30156
  s_mov_b64 exec, -1
SCX_109:
  v_lshrrev_b32 v18, 3, v0
  v_mul_u32_u24 v18, 4096, v18
  v_add_u32 v18, v18, v4
  s_mul_i32 s73, s4, 270336
  s_lshl_b32 s79, s5, 7
  s_add_u32 s73, s73, s79
  s_mul_i32 s79, s3, 67584
  s_add_u32 s73, s73, s79
  s_add_u32 s73, s73, 13369344
  s_lshl_b32 s78, s3, 11
  s_add_u32 m0, s78, 0
  s_mov_b32 s79, 1000000
SP_110:
  ds_read_b32 v3, v1 offset:30156
  s_waitcnt lgkmcnt(0)
  v_readfirstlane_b32 s78, v3
  s_nop 0
  s_cmp_ge_u32 s78, 1
  s_cbranch_scc1 SPE_111
  s_sub_u32 s79, s79, 1
  s_cbranch_scc0 SP_110
SPE_111:
  buffer_load_dwordx4 v18, s[28:31], s73 offen sc1 lds
  s_addk_i32 m0, 1024
  s_add_u32 s73, s73, 33792
  buffer_load_dwordx4 v18, s[28:31], s73 offen sc1 lds
  v_lshlrev_b32 v128, 16, v64
  v_and_b32 v129, 0xffff0000, v64
  v_lshlrev_b32 v130, 16, v65
  v_and_b32 v131, 0xffff0000, v65
  v_lshlrev_b32 v132, 16, v66
  v_and_b32 v133, 0xffff0000, v66
  v_lshlrev_b32 v134, 16, v67
  v_and_b32 v135, 0xffff0000, v67
  v_lshlrev_b32 v136, 16, v68
  v_and_b32 v137, 0xffff0000, v68
  v_lshlrev_b32 v138, 16, v69
  v_and_b32 v139, 0xffff0000, v69
  v_lshlrev_b32 v140, 16, v70
  v_and_b32 v141, 0xffff0000, v70
  v_lshlrev_b32 v142, 16, v71
  v_and_b32 v143, 0xffff0000, v71
  v_lshlrev_b32 v144, 16, v72
  v_and_b32 v145, 0xffff0000, v72
  v_lshlrev_b32 v146, 16, v73
  v_and_b32 v147, 0xffff0000, v73
  v_lshlrev_b32 v148, 16, v74
  v_and_b32 v149, 0xffff0000, v74
  v_lshlrev_b32 v150, 16, v75
  v_and_b32 v151, 0xffff0000, v75
  v_lshlrev_b32 v152, 16, v76
  v_and_b32 v153, 0xffff0000, v76
  v_lshlrev_b32 v154, 16, v77
  v_and_b32 v155, 0xffff0000, v77
  v_lshlrev_b32 v156, 16, v78
  v_and_b32 v157, 0xffff0000, v78
  v_lshlrev_b32 v158, 16, v79
  v_and_b32 v159, 0xffff0000, v79
  s_waitcnt vmcnt(0)
  s_mov_b64 exec, 1
  ds_add_u32 v1, v2 offset:30096
  s_mov_b64 exec, -1
  s_mov_b32 s79, 1000000
SP_112:
  ds_read_b32 v3, v1 offset:30096
  s_waitcnt lgkmcnt(0)
  v_readfirstlane_b32 s78, v3
  s_nop 0
  s_cmp_ge_u32 s78, 8
  s_cbranch_scc1 SPE_113
  s_sub_u32 s79, s79, 1
  s_cbranch_scc0 SP_112
SPE_113:
  ds_read_b64_tr_b16 v[80:81], v24 offset:0
  ds_read_b64_tr_b16 v[82:83], v24 offset:512
  ds_read_b64_tr_b16 v[84:85], v24 offset:64
  ds_read_b64_tr_b16 v[86:87], v24 offset:576
  s_waitcnt lgkmcnt(0)
  v_lshlrev_b32 v160, 16, v80
  v_and_b32 v161, 0xffff0000, v80
  v_lshlrev_b32 v162, 16, v81
  v_and_b32 v163, 0xffff0000, v81
  v_lshlrev_b32 v164, 16, v82
  v_and_b32 v165, 0xffff0000, v82
  v_lshlrev_b32 v166, 16, v83
  v_and_b32 v167, 0xffff0000, v83
  v_lshlrev_b32 v168, 16, v84
  v_and_b32 v169, 0xffff0000, v84
  v_lshlrev_b32 v170, 16, v85
  v_and_b32 v171, 0xffff0000, v85
  v_lshlrev_b32 v172, 16, v86
  v_and_b32 v173, 0xffff0000, v86
  v_lshlrev_b32 v174, 16, v87
  v_and_b32 v175, 0xffff0000, v87
  s_mov_b32 s86, 0xbfb8aa3b
  s_mov_b32 s87, 0xbfb8aa3b
  s_mov_b32 s79, 1000000
SP_114:
  ds_read_b32 v3, v1 offset:30120
  s_waitcnt lgkmcnt(0)
  v_readfirstlane_b32 s78, v3
  s_nop 0
  s_cmp_ge_u32 s78, 4
  s_cbranch_scc1 SPE_115
  s_sub_u32 s79, s79, 1
  s_cbranch_scc0 SP_114
SPE_115:
  ds_read_b128 v[176:179], v16 offset:0
  ds_read_b128 v[180:183], v16 offset:512
  ds_read_b128 v[184:187], v16 offset:16384
  ds_read_b128 v[188:191], v16 offset:16896
  ds_read_b128 v[192:195], v16 offset:32768
  ds_read_b128 v[196:199], v16 offset:33280
  ds_read_b128 v[200:203], v16 offset:49152
  ds_read_b128 v[204:207], v16 offset:49664
  s_waitcnt lgkmcnt(6)
  v_add_f32 v128, v128, v176
  v_add_f32 v129, v129, v177
  v_add_f32 v130, v130, v178
  v_add_f32 v131, v131, v179
  v_add_f32 v132, v132, v180
  v_add_f32 v133, v133, v181
  v_add_f32 v134, v134, v182
  v_add_f32 v135, v135, v183
  s_waitcnt lgkmcnt(4)
  v_add_f32 v128, v128, v184
  v_add_f32 v129, v129, v185
  v_add_f32 v130, v130, v186
  v_add_f32 v131, v131, v187
  v_add_f32 v132, v132, v188
  v_add_f32 v133, v133, v189
  v_add_f32 v134, v134, v190
  v_add_f32 v135, v135, v191
  s_waitcnt lgkmcnt(2)
  v_add_f32 v128, v128, v192
  v_add_f32 v129, v129, v193
  v_add_f32 v130, v130, v194
  v_add_f32 v131, v131, v195
  v_add_f32 v132, v132, v196
  v_add_f32 v133, v133, v197
  v_add_f32 v134, v134, v198
  v_add_f32 v135, v135, v199
  s_waitcnt lgkmcnt(0)
  v_add_f32 v128, v128, v200
  v_add_f32 v129, v129, v201
  v_add_f32 v130, v130, v202
  v_add_f32 v131, v131, v203
  v_add_f32 v132, v132, v204
  v_add_f32 v133, v133, v205
  v_add_f32 v134, v134, v206
  v_add_f32 v135, v135, v207
  v_mul_f32 v176, s86, v128
  v_mul_f32 v177, s86, v129
  v_mul_f32 v178, s86, v130
  v_mul_f32 v179, s86, v131
  v_mul_f32 v180, s86, v132
  v_mul_f32 v181, s86, v133
  v_mul_f32 v182, s86, v134
  v_mul_f32 v183, s86, v135
  v_exp_f32 v176, v176
  v_exp_f32 v177, v177
  v_exp_f32 v178, v178
  v_exp_f32 v179, v179
  v_exp_f32 v180, v180
  v_exp_f32 v181, v181
  v_exp_f32 v182, v182
  v_exp_f32 v183, v183
  v_add_f32 v176, 1.0, v176
  v_add_f32 v177, 1.0, v177
  v_add_f32 v178, 1.0, v178
  v_add_f32 v179, 1.0, v179
  v_add_f32 v180, 1.0, v180
  v_add_f32 v181, 1.0, v181
  v_add_f32 v182, 1.0, v182
  v_add_f32 v183, 1.0, v183
  v_mul_f32 v128, v128, v160
  v_mul_f32 v129, v129, v161
  v_mul_f32 v130, v130, v162
  v_mul_f32 v131, v131, v163
  v_mul_f32 v132, v132, v164
  v_mul_f32 v133, v133, v165
  v_mul_f32 v134, v134, v166
  v_mul_f32 v135, v135, v167
  v_rcp_f32 v176, v176
  v_rcp_f32 v177, v177
  v_rcp_f32 v178, v178
  v_rcp_f32 v179, v179
  v_rcp_f32 v180, v180
  v_rcp_f32 v181, v181
  v_rcp_f32 v182, v182
  v_rcp_f32 v183, v183
  v_fma_f32 v128, v128, v176, v144
  v_fma_f32 v129, v129, v177, v145
  v_fma_f32 v130, v130, v178, v146
  v_fma_f32 v131, v131, v179, v147
  v_fma_f32 v132, v132, v180, v148
  v_fma_f32 v133, v133, v181, v149
  v_fma_f32 v134, v134, v182, v150
  v_fma_f32 v135, v135, v183, v151
  v_cvt_pk_bf16_f32 v88, v128, v129
  v_cvt_pk_bf16_f32 v89, v130, v131
  v_cvt_pk_bf16_f32 v90, v132, v133
  v_cvt_pk_bf16_f32 v91, v134, v135
  buffer_store_dwordx4 v[88:91], v17, s[32:35], s72 offen
  s_mov_b32 s79, 1000000
SP_116:
  ds_read_b32 v3, v1 offset:30124
  s_waitcnt lgkmcnt(0)
  v_readfirstlane_b32 s78, v3
  s_nop 0
  s_cmp_ge_u32 s78, 4
  s_cbranch_scc1 SPE_117
  s_sub_u32 s79, s79, 1
  s_cbranch_scc0 SP_116
SPE_117:
  ds_read_b128 v[176:179], v16 offset:8192
  ds_read_b128 v[180:183], v16 offset:8704
  ds_read_b128 v[184:187], v16 offset:24576
  ds_read_b128 v[188:191], v16 offset:25088
  ds_read_b128 v[192:195], v16 offset:40960
  ds_read_b128 v[196:199], v16 offset:41472
  ds_read_b128 v[200:203], v16 offset:57344
  ds_read_b128 v[204:207], v16 offset:57856
  s_waitcnt lgkmcnt(6)
  v_pk_add_f32 v[136:137], v[136:137], v[176:177]
  v_pk_add_f32 v[138:139], v[138:139], v[178:179]
  v_pk_add_f32 v[140:141], v[140:141], v[180:181]
  v_pk_add_f32 v[142:143], v[142:143], v[182:183]
  s_waitcnt lgkmcnt(4)
  v_pk_add_f32 v[136:137], v[136:137], v[184:185]
  v_pk_add_f32 v[138:139], v[138:139], v[186:187]
  v_pk_add_f32 v[140:141], v[140:141], v[188:189]
  v_pk_add_f32 v[142:143], v[142:143], v[190:191]
  s_waitcnt lgkmcnt(2)
  v_pk_add_f32 v[136:137], v[136:137], v[192:193]
  v_pk_add_f32 v[138:139], v[138:139], v[194:195]
  v_pk_add_f32 v[140:141], v[140:141], v[196:197]
  v_pk_add_f32 v[142:143], v[142:143], v[198:199]
  s_waitcnt lgkmcnt(0)
  v_pk_add_f32 v[136:137], v[136:137], v[200:201]
  v_pk_add_f32 v[138:139], v[138:139], v[202:203]
  v_pk_add_f32 v[140:141], v[140:141], v[204:205]
  v_pk_add_f32 v[142:143], v[142:143], v[206:207]
  v_pk_mul_f32 v[176:177], v[136:137], s[86:87]
  v_pk_mul_f32 v[178:179], v[138:139], s[86:87]
  v_pk_mul_f32 v[180:181], v[140:141], s[86:87]
  v_pk_mul_f32 v[182:183], v[142:143], s[86:87]
  v_exp_f32 v176, v176
  v_exp_f32 v177, v177
  v_exp_f32 v178, v178
  v_exp_f32 v179, v179
  v_exp_f32 v180, v180
  v_exp_f32 v181, v181
  v_exp_f32 v182, v182
  v_exp_f32 v183, v183
  v_pk_add_f32 v[176:177], v[176:177], 1.0 op_sel_hi:[1,0]
  v_pk_add_f32 v[178:179], v[178:179], 1.0 op_sel_hi:[1,0]
  v_pk_add_f32 v[180:181], v[180:181], 1.0 op_sel_hi:[1,0]
  v_pk_add_f32 v[182:183], v[182:183], 1.0 op_sel_hi:[1,0]
  v_pk_mul_f32 v[136:137], v[136:137], v[168:169]
  v_pk_mul_f32 v[138:139], v[138:139], v[170:171]
  v_pk_mul_f32 v[140:141], v[140:141], v[172:173]
  v_pk_mul_f32 v[142:143], v[142:143], v[174:175]
  v_rcp_f32 v176, v176
  v_rcp_f32 v177, v177
  v_rcp_f32 v178, v178
  v_rcp_f32 v179, v179
  v_rcp_f32 v180, v180
  v_rcp_f32 v181, v181
  v_rcp_f32 v182, v182
  v_rcp_f32 v183, v183
  v_pk_fma_f32 v[136:137], v[136:137], v[176:177], v[152:153]
  v_pk_fma_f32 v[138:139], v[138:139], v[178:179], v[154:155]
  v_pk_fma_f32 v[140:141], v[140:141], v[180:181], v[156:157]
  v_pk_fma_f32 v[142:143], v[142:143], v[182:183], v[158:159]
  v_cvt_pk_bf16_f32 v92, v136, v137
  v_cvt_pk_bf16_f32 v93, v138, v139
  v_cvt_pk_bf16_f32 v94, v140, v141
  v_cvt_pk_bf16_f32 v95, v142, v143
  s_add_u32 s72, s72, 0x8000
  buffer_store_dwordx4 v[92:95], v17, s[32:35], s72 offen
  s_add_u32 s70, s2, s3
  s_cmp_lg_u32 s70, 0
  s_cbranch_scc1 EP_118
  s_mov_b64 exec, 1
  v_mov_b32 v3, s68
  buffer_store_dword v3, off, s[28:31], 0 sc1
  s_mov_b64 exec, -1
EP_118:
  s_endpgm
L_conv:
  s_waitcnt lgkmcnt(12)
  v_mfma_f32_16x16x32_bf16 v[56:59], v[220:223], v[224:227], v[56:59]
  ds_read2_b32 v[220:221], v11 offset0:0 offset1:1
  ds_read2_b32 v[222:223], v11 offset0:2 offset1:3
  v_mfma_f32_16x16x32_bf16 v[52:55], v[216:219], v[224:227], v[52:55]
  v_mfma_f32_16x16x32_bf16 v[56:59], v[216:219], v[228:231], v[56:59]
  ds_read2_b32 v[216:217], v11 offset0:128 offset1:129
  ds_read2_b32 v[218:219], v11 offset0:130 offset1:131
  v_mfma_f32_16x16x32_bf16 v[48:51], v[212:215], v[224:227], v[48:51]
  v_mfma_f32_16x16x32_bf16 v[52:55], v[212:215], v[228:231], v[52:55]
  v_mfma_f32_16x16x32_bf16 v[56:59], v[212:215], v[232:235], v[56:59]
  ds_read2_b32 v[212:213], v10 offset0:0 offset1:1
  ds_read2_b32 v[214:215], v10 offset0:2 offset1:3
  v_mfma_f32_16x16x32_bf16 v[44:47], v[208:211], v[224:227], v[44:47]
  v_mfma_f32_16x16x32_bf16 v[48:51], v[208:211], v[228:231], v[48:51]
  v_mfma_f32_16x16x32_bf16 v[52:55], v[208:211], v[232:235], v[52:55]
  v_mfma_f32_16x16x32_bf16 v[56:59], v[208:211], v[236:239], v[56:59]
  ds_read2_b32 v[208:209], v10 offset0:128 offset1:129
  ds_read2_b32 v[210:211], v10 offset0:130 offset1:131
  s_waitcnt lgkmcnt(8)
  v_mfma_f32_16x16x32_bf16 v[40:43], v[24:27], v[224:227], v[40:43]
  v_mfma_f32_16x16x32_bf16 v[36:39], v[20:23], v[224:227], v[36:39]
  v_mfma_f32_16x16x32_bf16 v[32:35], v[16:19], v[224:227], v[32:35]
  v_mfma_f32_16x16x32_bf16 v[28:31], v[12:15], v[224:227], v[28:31]
  ds_read_b128 v[224:227], v6 offset:0
  v_mfma_f32_16x16x32_bf16 v[44:47], v[24:27], v[228:231], v[44:47]
  v_mfma_f32_16x16x32_bf16 v[40:43], v[20:23], v[228:231], v[40:43]
  v_mfma_f32_16x16x32_bf16 v[36:39], v[16:19], v[228:231], v[36:39]
  v_mfma_f32_16x16x32_bf16 v[32:35], v[12:15], v[228:231], v[32:35]
  ds_read_b128 v[228:231], v6 offset:512
  v_mfma_f32_16x16x32_bf16 v[48:51], v[24:27], v[232:235], v[48:51]
  v_mfma_f32_16x16x32_bf16 v[44:47], v[20:23], v[232:235], v[44:47]
  v_mfma_f32_16x16x32_bf16 v[40:43], v[16:19], v[232:235], v[40:43]
  v_mfma_f32_16x16x32_bf16 v[36:39], v[12:15], v[232:235], v[36:39]
  ds_read_b128 v[232:235], v6 offset:1024
  v_mfma_f32_16x16x32_bf16 v[52:55], v[24:27], v[236:239], v[52:55]
  v_mfma_f32_16x16x32_bf16 v[48:51], v[20:23], v[236:239], v[48:51]
  v_mfma_f32_16x16x32_bf16 v[44:47], v[16:19], v[236:239], v[44:47]
  v_mfma_f32_16x16x32_bf16 v[40:43], v[12:15], v[236:239], v[40:43]
  ds_read_b128 v[236:239], v6 offset:1536
  v_mfma_f32_16x16x32_bf16 v[56:59], v[24:27], v[240:243], v[56:59]
  v_mfma_f32_16x16x32_bf16 v[52:55], v[20:23], v[240:243], v[52:55]
  v_mfma_f32_16x16x32_bf16 v[48:51], v[16:19], v[240:243], v[48:51]
  v_mfma_f32_16x16x32_bf16 v[44:47], v[12:15], v[240:243], v[44:47]
  ds_read_b128 v[240:243], v6 offset:2048
  ds_read2_b32 v[24:25], v9 offset0:0 offset1:1
  ds_read2_b32 v[26:27], v9 offset0:2 offset1:3
  v_mfma_f32_16x16x32_bf16 v[56:59], v[20:23], v[244:247], v[56:59]
  v_mfma_f32_16x16x32_bf16 v[52:55], v[16:19], v[244:247], v[52:55]
  v_mfma_f32_16x16x32_bf16 v[48:51], v[12:15], v[244:247], v[48:51]
  ds_read_b128 v[244:247], v6 offset:2560
  ds_read2_b32 v[20:21], v9 offset0:128 offset1:129
  ds_read2_b32 v[22:23], v9 offset0:130 offset1:131
  v_mfma_f32_16x16x32_bf16 v[56:59], v[16:19], v[248:251], v[56:59]
  v_mfma_f32_16x16x32_bf16 v[52:55], v[12:15], v[248:251], v[52:55]
  ds_read_b128 v[248:251], v6 offset:3072
  ds_read2_b32 v[16:17], v8 offset0:0 offset1:1
  ds_read2_b32 v[18:19], v8 offset0:2 offset1:3
  v_mfma_f32_16x16x32_bf16 v[56:59], v[12:15], v[252:255], v[56:59]
  ds_read_b128 v[252:255], v6 offset:3584
  ds_read2_b32 v[12:13], v8 offset0:128 offset1:129
  ds_read2_b32 v[14:15], v8 offset0:130 offset1:131
  v_subrev_u32 v6, 64, v6
  v_subrev_u32 v8, 64, v8
  v_subrev_u32 v9, 64, v9
  v_subrev_u32 v10, 64, v10
  v_subrev_u32 v11, 64, v11
  s_setpc_b64 s[88:89]
L_codeend:
.section .rodata,"a"
.p2align 6
.amdhsa_kernel recurrent_scan__ssm_conv_s4__mixer_s_mlp__prompt_kernel
  .amdhsa_next_free_vgpr 256
  .amdhsa_next_free_sgpr 102
  .amdhsa_accum_offset 256
  .amdhsa_group_segment_fixed_size 0
  .amdhsa_kernarg_size 136
  .amdhsa_user_sgpr_count 2
  .amdhsa_user_sgpr_kernarg_segment_ptr 1
  .amdhsa_system_sgpr_workgroup_id_x 1
.end_amdhsa_kernel
```
